```python
import torch

def _softmax(x, axis=-1):
    return torch.softmax(x, dim=axis)
def _gelu(x):
    return torch.nn.functional.gelu(x, approximate="tanh")
def _silu(x):
    return torch.nn.functional.silu(x)
def _sigmoid(x):
    return torch.sigmoid(x)
def _layernorm(x, axis=-1, eps=1e-5):
    m = x.mean(dim=axis, keepdim=True)
    v = x.var(dim=axis, keepdim=True, unbiased=False)
    return (x - m) / torch.sqrt(v + eps)
def _scatter_add(tgt, idx, src, axis=0):
    return tgt.clone().index_add_(axis, idx, src)
def _segment_sum(src, seg, n):
    out = torch.zeros((n,) + src.shape[1:], dtype=src.dtype)
    return out.index_add_(0, seg, src)
def _pad(x, pw):
    flat = tuple(v for pair in reversed(pw) for v in pair)
    return torch.nn.functional.pad(x, flat)

kernel_name = 'parallel_sum__ssm_conv_s5__dense_activation_mish__prompt'

def setup_inputs():

    _w = (lambda a: (lambda t: t.to(torch.bfloat16) if t.is_floating_point() else t)(torch.as_tensor(a)))
    def _A_setup():
        B, S, D = 1, 2048, 448
        P = D
        Lambda_re = -0.5 * (lambda _x: torch.exp(torch.as_tensor(_x)))((lambda *s: torch.randn(*s, dtype=torch.bfloat16) * 0.2)(P))
        Lambda_im = (lambda *s: torch.randn(*s, dtype=torch.bfloat16) * 0.8)(P) * 1.0
        B_re = (lambda *s: torch.randn(*s, dtype=torch.bfloat16) * 0.2)(P, D) * (D ** -0.5)
        B_im = (lambda *s: torch.randn(*s, dtype=torch.bfloat16) * 0.2)(P, D) * (D ** -0.5)
        C_re = (lambda *s: torch.randn(*s, dtype=torch.bfloat16) * 0.2)(D, P) * (P ** -0.5)
        C_im = (lambda *s: torch.randn(*s, dtype=torch.bfloat16) * 0.2)(D, P) * (P ** -0.5)
        log_dt = (lambda *s: torch.randn(*s, dtype=torch.bfloat16) * 0.2)(P) * 0.3 - 2.0
        Dskip = (lambda *s: torch.randn(*s, dtype=torch.bfloat16) * 0.05)(D)
        return {
            "x": _w((lambda *s: torch.randn(*s, dtype=torch.bfloat16) * 0.05)(B, S, D)),
            "Lambda_re": _w(Lambda_re),
            "Lambda_im": _w(Lambda_im),
            "B_re": _w(B_re),
            "B_im": _w(B_im),
            "C_re": _w(C_re),
            "C_im": _w(C_im),
            "log_dt": _w(log_dt),
            "Dskip": _w(Dskip),
        }
    _A_in = _A_setup()

    def _B_setup():
        B, S, D, F = 1, 2048, 448, 1792
        return {
            "x": _w((lambda *s: torch.randn(*s, dtype=torch.bfloat16) * 0.05)(B, S, D)),
            "w1": _w((lambda *s: torch.randn(*s, dtype=torch.bfloat16) * 0.8)(D, F) * (D ** -0.5)),
            "b1": _w((lambda *s: torch.randn(*s, dtype=torch.bfloat16) * 0.2)(F)),
            "w2": _w((lambda *s: torch.randn(*s, dtype=torch.bfloat16) * 0.2)(F, D) * (F ** -0.5)),
        }
    _B_in = _B_setup()

    return {
        "A_x": _A_in["x"],
        "A_Lambda_re": _A_in["Lambda_re"],
        "A_Lambda_im": _A_in["Lambda_im"],
        "A_B_re": _A_in["B_re"],
        "A_B_im": _A_in["B_im"],
        "A_C_re": _A_in["C_re"],
        "A_C_im": _A_in["C_im"],
        "A_log_dt": _A_in["log_dt"],
        "A_Dskip": _A_in["Dskip"],
        "B_x": _B_in["x"],
        "B_w1": _B_in["w1"],
        "B_b1": _B_in["b1"],
        "B_w2": _B_in["w2"],
    }

def reference(A_x, A_Lambda_re, A_Lambda_im, A_B_re, A_B_im, A_C_re, A_C_im, A_log_dt, A_Dskip, B_x, B_w1, B_b1, B_w2):
    def _A_ref(x, Lambda_re, Lambda_im, B_re, B_im, C_re, C_im, log_dt, Dskip):
        Bsz, L, H = x.shape
        Lam = Lambda_re + 1j * Lambda_im
        Bmat = B_re + 1j * B_im
        Cmat = C_re + 1j * C_im
        dt = torch.exp(log_dt)
        Lam_bar = torch.exp(dt * Lam)
        B_bar = ((Lam_bar - 1.0) / Lam)[:, None] * Bmat
        Bu = torch.einsum("bld,pd->blp", x + 0j, B_bar)
        h = torch.zeros_like(Bu[:, 0, :])
        hs = []
        for t in range(L):
            h = Lam_bar[None, :] * h + Bu[:, t, :]
            hs.append(h)
        hseq = torch.stack(hs, 1)
        y = 2.0 * torch.einsum("blp,dp->bld", hseq, Cmat).real + x * Dskip[None, None, :]
        return y

    def _B_ref(x, w1, b1, w2):
        h = torch.einsum("bsd,df->bsf", x, w1) + b1
        sp = torch.log1p(torch.exp(-torch.abs(h))) + torch.where(h > 0, h, torch.zeros_like(h))
        act = h * torch.tanh(sp)
        return torch.einsum("bsf,fd->bsd", act, w2)

    x = A_x
    xn = _layernorm(x, axis=-1)
    return x + _A_ref(xn, A_Lambda_re, A_Lambda_im, A_B_re, A_B_im, A_C_re, A_C_im, A_log_dt, A_Dskip) + _B_ref(xn, B_w1, B_b1, B_w2)
```

```asm
; @launch grid=(256,1,1) block=(256,1,1) lds=163840
.amdgcn_target "amdgcn-amd-amdhsa--gfx950"
.text
.globl parallel_sum__ssm_conv_s5__dense_activation_mish__prompt_kernel
.p2align 8
.type parallel_sum__ssm_conv_s5__dense_activation_mish__prompt_kernel,@function
parallel_sum__ssm_conv_s5__dense_activation_mish__prompt_kernel:
    s_load_dwordx16 s[4:19], s[0:1], 0
    s_load_dwordx16 s[20:35], s[0:1], 64
    s_getpc_b64 s[36:37]
    s_cmp_ge_u32 s2, 256
    s_cbranch_scc1 L_end
    s_lshr_b32 s98, s2, 3
    v_and_b32 v11, 7, v0
    v_lshl_add_u32 v8, s98, 3, v11
    v_lshlrev_b32 v8, 7, v8
    v_min_u32 v8, L_hot_end-parallel_sum__ssm_conv_s5__dense_activation_mish__prompt_kernel-32, v8
    global_load_dword v171, v8, s[36:37]
    v_lshrrev_b32 v8, 6, v0
    v_and_b32 v9, 63, v0
    v_readfirstlane_b32 s90, v8
    s_and_b32 s99, s2, 7
    s_bitcmp1_b32 s2, 0
    s_cselect_b32 s101, 5, 3
    s_cselect_b32 s100, 29, 0
    s_sub_u32 s98, s98, s101
    s_cbranch_scc1 L_helper
    s_add_u32 s98, s98, s100
    s_lshr_b32 s91, s98, 3
    s_and_b32 s98, s98, 7
    s_lshr_b32 s99, s99, 1
    s_lshl3_add_u32 s92, s99, s98
    v_lshrrev_b32 v10, 3, v9
    s_lshl2_add_u32 s98, s92, s90
    s_mul_i32 s98, s98, 14336
    v_mul_u32_u24 v12, 896, v10
    v_lshlrev_b32 v13, 4, v11
    v_add3_u32 v14, v12, v13, s98
    v_add_u32 v15, 7168, v14
    s_lshl_b32 s80, s91, 7
    s_mov_b32 s38, 1835008
    s_mov_b32 s39, 0x20000
    s_sub_u32 s95, s2, 32
    s_waitcnt lgkmcnt(0)
    s_mov_b64 s[36:37], s[4:5]
    buffer_load_dwordx4 v[96:99], v14, s[36:39], s80 offen
    buffer_load_dwordx4 v[124:127], v15, s[36:39], s80 offen
    s_add_u32 s81, s80, 128
    s_cmp_eq_u32 s81, 896
    s_cselect_b32 s81, 0, s81
    buffer_load_dwordx4 v[100:103], v14, s[36:39], s81 offen
    s_add_u32 s82, s81, 128
    s_cmp_eq_u32 s82, 896
    s_cselect_b32 s82, 0, s82
    buffer_load_dwordx4 v[104:107], v14, s[36:39], s82 offen
    s_add_u32 s83, s82, 128
    s_cmp_eq_u32 s83, 896
    s_cselect_b32 s83, 0, s83
    buffer_load_dwordx4 v[108:111], v14, s[36:39], s83 offen
    s_add_u32 s84, s83, 128
    s_cmp_eq_u32 s84, 896
    s_cselect_b32 s84, 0, s84
    buffer_load_dwordx4 v[112:115], v14, s[36:39], s84 offen
    s_add_u32 s85, s84, 128
    s_cmp_eq_u32 s85, 896
    s_cselect_b32 s85, 0, s85
    buffer_load_dwordx4 v[116:119], v14, s[36:39], s85 offen
    s_add_u32 s86, s85, 128
    s_cmp_eq_u32 s86, 896
    s_cselect_b32 s86, 0, s86
    buffer_load_dwordx4 v[120:123], v14, s[36:39], s86 offen
    v_and_b32 v2, 31, v9
    v_lshrrev_b32 v3, 5, v9
    v_bfe_u32 v4, v9, 4, 1
    v_lshl_add_u32 v4, v4, 3, v11
    s_lshl2_add_u32 s98, s91, s90
    s_lshl_b32 s99, s98, 5
    v_lshl_add_u32 v170, v4, 1, s99
    s_lshl3_add_u32 s100, s91, s90
    s_lshl_b32 s100, s100, 6
    v_lshl_add_u32 v176, v2, 1, s100
    v_add_u32 v184, s80, v13
    v_and_b32 v5, 1, v10
    global_load_dwordx4 v[184:187], v184, s[20:21]
    global_load_ushort v172, v176, s[26:27]
    s_sub_u32 s40, s10, 4096
    s_subb_u32 s41, s11, 0
    s_mov_b32 s42, 405504
    s_mov_b32 s43, 0x20000
    s_sub_u32 s44, s12, 4096
    s_subb_u32 s45, s13, 0
    s_mov_b64 s[46:47], s[42:43]
    s_sub_u32 s48, s14, 4096
    s_subb_u32 s49, s15, 0
    s_mov_b64 s[50:51], s[42:43]
    s_sub_u32 s52, s16, 4096
    s_subb_u32 s53, s17, 0
    s_mov_b64 s[54:55], s[42:43]
    s_sub_u32 s60, s24, 4096
    s_subb_u32 s61, s25, 0
    s_mov_b32 s62, 1609728
    s_mov_b32 s63, 0x20000
    s_sub_u32 s64, s28, 4096
    s_subb_u32 s65, s29, 0
    s_mov_b64 s[66:67], s[62:63]
    s_cmp_ge_u32 s90, 2
    s_cselect_b32 s87, s82, s81
    s_cselect_b32 s88, s84, s83
    s_cselect_b32 s89, s86, s85
    s_lshl_b32 s99, s98, 12
    s_add_u32 s72, s34, s99
    s_addc_u32 s73, s35, 0
    s_mov_b32 s74, 4096
    s_mov_b32 s75, 0x20000
    s_lshl_b32 s101, s90, 12
    s_add_u32 s93, s101, 28672
    s_mul_i32 s99, s98, 14336
    s_add_u32 s99, s99, 4096
    v_lshrrev_b32 v13, 1, v10
    v_xor_b32 v13, v13, v11
    v_lshl_add_u32 v13, v13, 4, v12
    v_xor_b32 v8, 64, v13
    v_add_u32 v192, s99, v13
    s_sub_u32 s99, s99, 1024
    v_add_u32 v193, s99, v8
    v_add_u32 v194, 5120, v192
    v_add_u32 v195, 5120, v193
    s_and_b32 s98, s90, 1
    s_lshr_b32 s100, s90, 1
    s_mul_i32 s99, s98, 28672
    s_add_u32 s99, s99, s80
    s_add_u32 s99, s99, 4096
    v_add_u32 v204, s99, v13
    s_add_u32 s99, s99, 6144
    v_add_u32 v205, s99, v8
    v_add_u32 v206, 12288, v204
    v_add_u32 v207, 12288, v205
    v_and_b32 v13, 2, v10
    v_lshlrev_b32 v13, 1, v13
    v_xor_b32 v13, v13, v11
    v_lshlrev_b32 v13, 4, v13
    s_lshl2_add_u32 s94, s91, s98
    s_mul_i32 s94, s94, 57344
    s_add_u32 s94, s94, 4096
    v_add3_u32 v200, v13, v12, s94
    v_lshl_add_u32 v14, v10, 7, v13
    v_add_u32 v201, 6144, v200
    v_add_u32 v202, 26624, v200
    v_add_u32 v203, 32768, v200
    s_mul_i32 s94, s98, 114688
    s_lshl2_add_u32 s99, s91, s100
    s_lshl_b32 s99, s99, 7
    s_add_u32 s94, s94, s99
    s_add_u32 s94, s94, 4096
    v_lshlrev_b32 v12, 2, v12
    v_add3_u32 v196, v13, v12, s94
    v_add_u32 v197, 27648, v196
    v_add_u32 v198, 55296, v196
    v_add_u32 v199, 82944, v196
    v_lshlrev_b32 v1, 4, v9
    v_bfe_u32 v12, v9, 1, 3
    v_xor_b32 v12, v12, v3
    v_lshlrev_b32 v12, 4, v12
    v_lshl_add_u32 v208, v2, 7, v12
    s_add_u32 s99, s101, 32768
    v_xor_b32 v209, 32, v208
    v_xor_b32 v210, 64, v208
    v_xor_b32 v211, 96, v208
    v_add_u32 v220, s99, v208
    v_add_u32 v224, 65536, v220
    v_add_u32 v221, s99, v209
    v_add_u32 v225, 65536, v221
    v_add_u32 v222, s99, v210
    v_add_u32 v226, 65536, v222
    v_add_u32 v223, s99, v211
    v_add_u32 v227, 65536, v223
    v_and_b32 v8, 3, v9
    v_xor_b32 v8, v8, v3
    v_lshlrev_b32 v8, 5, v8
    v_and_b32 v12, 4, v9
    v_lshl_add_u32 v8, v12, 2, v8
    v_lshl_add_u32 v8, v4, 7, v8
    v_lshl_add_u32 v8, v5, 13, v8
    s_lshl_b32 s99, s90, 11
    v_add_u32 v237, s99, v1
    s_add_u32 s99, s99, 16384
    v_add_u32 v238, s99, v8
    v_lshlrev_b32 v8, 31, v5
    v_xor_b32 v253, 1.0, v8
    s_sub_u32 s99, 31, s92
    s_lshl_b32 s99, s99, 7
    v_lshl_add_u32 v12, v4, 3, s99
    v_lshl_add_u32 v214, v5, 20, v12
    v_lshl_add_u32 v214, v3, 20, v214
    v_lshl_add_u32 v8, v3, 1, v5
    v_lshl_add_u32 v12, v8, 10, v12
    v_add_u32 v4, 128, v12
    v_bfe_u32 v13, v9, 3, 1
    v_bfe_u32 v12, v9, 2, 2
    v_and_b32 v5, 3, v9
    v_xor_b32 v8, s98, v13
    v_lshlrev_b32 v8, 6, v8
    v_lshl_add_u32 v8, v12, 7, v8
    v_lshl_add_u32 v8, v5, 3, v8
    v_and_b32 v5, 16, v9
    v_lshl_add_u32 v8, v5, 1, v8
    s_lshl_b32 s99, s100, 13
    s_add_u32 s99, s99, 32768
    v_add_u32 v8, s99, v8
    v_lshl_add_u32 v212, v3, 10, v8
    v_lshl_add_u32 v230, v3, 9, v8
    v_lshl_add_u32 v236, s100, 10, v1
    s_lshl_b32 s99, s100, 12
    s_sub_u32 s99, 24576, s99
    v_mul_u32_u24 v255, 1536, v3
    v_add3_u32 v255, v255, v230, s99
    v_add_u32 v213, 65536, v212
    v_add_u32 v231, 65536, v230
    v_lshl_add_u32 v8, v13, 6, v5
    v_lshl_add_u32 v8, v12, 7, v8
    v_lshl_add_u32 v8, v3, 10, v8
    v_xor_b32 v5, v9, v12
    v_and_b32 v5, 1, v5
    v_lshl_add_u32 v8, v5, 5, v8
    v_and_b32 v5, 2, v9
    v_lshl_add_u32 v8, v5, 2, v8
    v_add_u32 v232, 16384, v8
    v_xor_b32 v233, 64, v232
    v_xor_b32 v234, 16, v232
    v_xor_b32 v235, 0x50, v232
    v_lshrrev_b32 v8, 2, v10
    v_and_b32 v12, 3, v10
    v_lshl_add_u32 v12, v8, 3, v12
    v_lshl_add_u32 v12, s98, 2, v12
    v_bfe_u32 v8, v12, 1, 3
    v_xor_b32 v8, v8, v11
    v_lshlrev_b32 v8, 4, v8
    v_lshl_add_u32 v12, v12, 7, v8
    v_lshl_add_u32 v12, s100, 12, v12
    s_lshl_b32 s99, s90, 11
    s_add_u32 s99, s99, 57344
    v_add_u32 v13, s99, v14
    s_mov_b32 s28, 1069066811
    s_mov_b32 s29, 1069066811
    v_cmp_eq_u32 vcc, 0, v3
    v_mov_b32 v8, 3140239289
    v_mov_b32 v181, 14061
    v_cndmask_b32 v180, 0, v8, vcc
    v_cndmask_b32 v181, 0, v181, vcc
    v_mov_b32 v174, 0
    v_mov_b32 v175, 0
    v_mov_b32 v178, 0
    v_mov_b32 v179, 0
    v_mov_b32 v182, 0
    v_mov_b32 v183, 0
    v_bfe_u32 v8, v9, 2, 2
    v_lshrrev_b32 v5, 4, v9
    v_cmp_eq_u32 vcc, v8, v5
    v_mov_b32 v8, 0x3f803f80
    s_nop 0
    v_cndmask_b32 v216, 0, v8, vcc
    v_cndmask_b32 v217, 0, v8, vcc
    v_cndmask_b32 v218, 0, v8, vcc
    v_cndmask_b32 v219, 0, v8, vcc
    global_load_ushort v176, v176, s[26:27] offset:256
    s_mov_b64 exec, 0
    s_cmp_eq_u32 s90, 0
    s_cbranch_scc1 L_page1
    s_cmp_eq_u32 s90, 1
    s_cbranch_scc1 L_page2
    s_cmp_eq_u32 s90, 2
    s_cbranch_scc1 L_page3
    s_cmp_eq_u32 s90, 3
    s_cbranch_scc1 L_page4
L_back0:
    s_mov_b64 exec, -1
    s_branch L_body
L_helper:
    s_mov_b32 s95, s2
    s_sub_u32 s98, s2, 24
    s_cselect_b32 s98, 0, s98
    s_add_u32 s98, s98, 1
    s_lshr_b32 s98, s98, 1
    s_sub_u32 s2, s2, s98
    s_cmp_ge_u32 s2, 28
    s_cbranch_scc1 L_filler
    s_mul_i32 s100, s2, 224
    v_min_u32 v3, 223, v0
    v_add_u32 v3, s100, v3
    v_lshrrev_b32 v4, 1, v3
    v_lshlrev_b32 v4, 7, v4
    v_and_b32 v5, 1, v3
    v_lshl_add_u32 v9, v5, 24, v4
    v_xor_b32 v10, 0x1000000, v9
    v_lshlrev_b32 v4, 2, v4
    v_lshl_add_u32 v4, v5, 7, v4
    s_waitcnt lgkmcnt(0)
    s_mov_b64 s[60:61], s[24:25]
    s_mov_b32 s62, 1605632
    s_mov_b32 s63, 0x20000
    s_mov_b64 s[40:41], s[10:11]
    s_mov_b32 s42, 401408
    s_mov_b32 s43, 0x20000
    s_mov_b64 s[44:45], s[12:13]
    s_mov_b64 s[46:47], s[42:43]
    s_bfm_b64 exec, 16, 0
    buffer_load_dword v12, v4, s[60:63], 0 offen
    s_waitcnt vmcnt(3)
    s_bfm_b64 exec, 16, 16
    buffer_load_dword v12, v4, s[60:63], 0 offen
    s_waitcnt vmcnt(3)
    s_bfm_b64 exec, 16, 32
    buffer_load_dword v12, v4, s[60:63], 0 offen
    s_waitcnt vmcnt(3)
    s_bfm_b64 exec, 16, 48
    buffer_load_dword v12, v4, s[60:63], 0 offen
    s_waitcnt vmcnt(3)
    s_mov_b64 exec, -1
    s_lshr_b32 s100, s2, 2
    s_mul_i32 s100, s100, 114688
    s_add_u32 s101, s100, 114688
    v_lshlrev_b32 v3, 7, v3
    s_mov_b64 s[64:65], s[28:29]
    s_mov_b64 s[66:67], s[62:63]
    s_mov_b64 s[48:49], s[14:15]
    s_mov_b64 s[50:51], s[42:43]
    s_mov_b64 s[52:53], s[16:17]
    s_mov_b64 s[54:55], s[42:43]
    s_bfm_b64 exec, 16, 0
    buffer_load_dword v12, v9, s[40:43], 0 offen
    buffer_load_dword v12, v10, s[44:47], 0 offen
    s_waitcnt vmcnt(4)
    s_bfm_b64 exec, 16, 16
    buffer_load_dword v12, v9, s[40:43], 0 offen
    buffer_load_dword v12, v10, s[44:47], 0 offen
    s_waitcnt vmcnt(4)
    s_bfm_b64 exec, 16, 32
    buffer_load_dword v12, v9, s[40:43], 0 offen
    buffer_load_dword v12, v10, s[44:47], 0 offen
    s_waitcnt vmcnt(4)
    s_bfm_b64 exec, 16, 48
    buffer_load_dword v12, v9, s[40:43], 0 offen
    buffer_load_dword v12, v10, s[44:47], 0 offen
    s_waitcnt vmcnt(4)
    s_mov_b64 exec, -1
    s_bfm_b64 exec, 8, 0
    buffer_load_dword v12, v4, s[60:63], 0 offen offset:256
    s_waitcnt vmcnt(2)
    s_bfm_b64 exec, 8, 8
    buffer_load_dword v12, v4, s[60:63], 0 offen offset:256
    s_waitcnt vmcnt(2)
    s_bfm_b64 exec, 8, 16
    buffer_load_dword v12, v4, s[60:63], 0 offen offset:256
    s_waitcnt vmcnt(2)
    s_bfm_b64 exec, 8, 24
    buffer_load_dword v12, v4, s[60:63], 0 offen offset:256
    s_waitcnt vmcnt(2)
    s_bfm_b64 exec, 8, 32
    buffer_load_dword v12, v4, s[60:63], 0 offen offset:256
    s_waitcnt vmcnt(2)
    s_bfm_b64 exec, 8, 40
    buffer_load_dword v12, v4, s[60:63], 0 offen offset:256
    s_waitcnt vmcnt(2)
    s_bfm_b64 exec, 8, 48
    buffer_load_dword v12, v4, s[60:63], 0 offen offset:256
    s_waitcnt vmcnt(2)
    s_bfm_b64 exec, 8, 56
    buffer_load_dword v12, v4, s[60:63], 0 offen offset:256
    s_waitcnt vmcnt(2)
    s_mov_b64 exec, -1
    s_bfm_b64 exec, 8, 0
    buffer_load_dword v12, v3, s[64:67], s100 offen
    s_waitcnt vmcnt(1)
    s_bfm_b64 exec, 8, 8
    buffer_load_dword v12, v3, s[64:67], s100 offen
    s_waitcnt vmcnt(1)
    s_bfm_b64 exec, 8, 16
    buffer_load_dword v12, v3, s[64:67], s100 offen
    s_waitcnt vmcnt(1)
    s_bfm_b64 exec, 8, 24
    buffer_load_dword v12, v3, s[64:67], s100 offen
    s_waitcnt vmcnt(1)
    s_bfm_b64 exec, 8, 32
    buffer_load_dword v12, v3, s[64:67], s100 offen
    s_waitcnt vmcnt(1)
    s_bfm_b64 exec, 8, 40
    buffer_load_dword v12, v3, s[64:67], s100 offen
    s_waitcnt vmcnt(1)
    s_bfm_b64 exec, 8, 48
    buffer_load_dword v12, v3, s[64:67], s100 offen
    s_waitcnt vmcnt(1)
    s_bfm_b64 exec, 8, 56
    buffer_load_dword v12, v3, s[64:67], s100 offen
    s_waitcnt vmcnt(1)
    s_mov_b64 exec, -1
    s_bfm_b64 exec, 8, 0
    buffer_load_dword v12, v3, s[64:67], s101 offen
    s_waitcnt vmcnt(3)
    s_bfm_b64 exec, 8, 8
    buffer_load_dword v12, v3, s[64:67], s101 offen
    s_waitcnt vmcnt(3)
    s_bfm_b64 exec, 8, 16
    buffer_load_dword v12, v3, s[64:67], s101 offen
    s_waitcnt vmcnt(3)
    s_bfm_b64 exec, 8, 24
    buffer_load_dword v12, v3, s[64:67], s101 offen
    s_waitcnt vmcnt(3)
    s_bfm_b64 exec, 8, 32
    buffer_load_dword v12, v3, s[64:67], s101 offen
    s_waitcnt vmcnt(3)
    s_bfm_b64 exec, 8, 40
    buffer_load_dword v12, v3, s[64:67], s101 offen
    s_waitcnt vmcnt(3)
    s_bfm_b64 exec, 8, 48
    buffer_load_dword v12, v3, s[64:67], s101 offen
    s_waitcnt vmcnt(3)
    s_bfm_b64 exec, 8, 56
    buffer_load_dword v12, v3, s[64:67], s101 offen
    s_waitcnt vmcnt(3)
    s_mov_b64 exec, -1
    s_bfm_b64 exec, 8, 0
    buffer_load_dword v12, v9, s[48:51], 0 offen
    buffer_load_dword v12, v10, s[52:55], 0 offen
    s_waitcnt vmcnt(6)
    s_bfm_b64 exec, 8, 8
    buffer_load_dword v12, v9, s[48:51], 0 offen
    buffer_load_dword v12, v10, s[52:55], 0 offen
    s_waitcnt vmcnt(6)
    s_bfm_b64 exec, 8, 16
    buffer_load_dword v12, v9, s[48:51], 0 offen
    buffer_load_dword v12, v10, s[52:55], 0 offen
    s_waitcnt vmcnt(6)
    s_bfm_b64 exec, 8, 24
    buffer_load_dword v12, v9, s[48:51], 0 offen
    buffer_load_dword v12, v10, s[52:55], 0 offen
    s_waitcnt vmcnt(6)
    s_bfm_b64 exec, 8, 32
    buffer_load_dword v12, v9, s[48:51], 0 offen
    buffer_load_dword v12, v10, s[52:55], 0 offen
    s_waitcnt vmcnt(6)
    s_bfm_b64 exec, 8, 40
    buffer_load_dword v12, v9, s[48:51], 0 offen
    buffer_load_dword v12, v10, s[52:55], 0 offen
    s_waitcnt vmcnt(6)
    s_bfm_b64 exec, 8, 48
    buffer_load_dword v12, v9, s[48:51], 0 offen
    buffer_load_dword v12, v10, s[52:55], 0 offen
    s_waitcnt vmcnt(6)
    s_bfm_b64 exec, 8, 56
    buffer_load_dword v12, v9, s[48:51], 0 offen
    buffer_load_dword v12, v10, s[52:55], 0 offen
    s_waitcnt vmcnt(6)
    s_mov_b64 exec, -1
    s_waitcnt vmcnt(0)
    s_branch L_helped
L_filler:
    v_lshlrev_b32 v1, 4, v0
    v_mov_b32 v20, -1
    v_mov_b32 v21, -1
    v_mov_b32 v22, -1
    v_mov_b32 v23, -1
    s_sub_u32 s101, s2, 28
    s_mul_i32 s100, s101, 94208
    s_add_u32 s98, s100, 94208
    s_lshl_b32 s101, s101, 6
    v_lshrrev_b32 v6, 2, v0
    v_lshl_add_u32 v6, v6, 8, v1
    s_waitcnt lgkmcnt(0)
    s_mov_b64 s[76:77], s[34:35]
    s_mov_b32 s78, 16777216
    s_mov_b32 s79, 0x20000
    s_mov_b64 s[72:73], s[32:33]
    s_mov_b32 s74, 256
    s_mov_b32 s75, 0x20000
L_fill:
    buffer_store_dwordx4 v[20:23], v1, s[76:79], s100 offen sc1
    s_add_u32 s100, s100, 4096
    s_cmp_lt_u32 s100, s98
    s_cbranch_scc1 L_fill
    v_mov_b32 v24, 0x100
    s_waitcnt vmcnt(0)
    s_barrier
    s_cmp_lg_u32 s90, 0
    s_cbranch_scc1 L_helped
    v_mov_b32 v25, 0
    v_mov_b32 v26, 0
    v_mov_b32 v27, 0
    buffer_store_dwordx4 v[24:27], v6, s[72:75], s101 offen sc1
    v_lshrrev_b32 v8, 7, v1
    v_lshl_add_u32 v8, v8, 24, v1
    s_lshr_b32 s94, s101, 5
    s_lshl_b32 s100, s94, 21
    s_add_u32 s100, s100, 1277952
    s_getreg_b32 s92, hwreg(HW_REG_XCC_ID, 2, 1)
    s_mul_i32 s92, s92, 3
    s_mov_b32 s91, 1
L_page_probe:
    s_mov_b32 s98, 0
    s_mov_b32 s99, 6
    s_waitcnt vmcnt(0)
L_probe:
    s_memtime s[4:5]
    buffer_store_dwordx4 v[20:23], v8, s[76:79], s100 offen sc1
    s_waitcnt vmcnt(0)
    s_memtime s[6:7]
    s_xor_b32 s100, s100, 0x2000
    s_add_u32 s100, s100, 640
    s_waitcnt lgkmcnt(0)
    s_sub_u32 s6, s6, s4
    s_sub_u32 s98, s6, s98
    s_sub_u32 s99, s99, 1
    s_cmp_lg_u32 s99, 0
    s_cbranch_scc1 L_probe
    s_cmp_lt_i32 s98, 0
    s_cselect_b32 s98, s91, 0
    s_xor_b32 s92, s92, s98
    s_add_u32 s100, s100, 2093312
    s_lshl_b32 s91, s91, 1
    s_cmp_eq_u32 s91, 2
    s_cbranch_scc1 L_page_probe
    s_lshl_b32 s92, s92, s94
    s_or_b32 s92, s92, 0x300
    v_mov_b32 v24, s92
    buffer_store_dwordx4 v[24:27], v6, s[72:75], s101 offen sc1
L_helped:
    s_endpgm
L_end:
    s_endpgm
.p2align 12
L_body:
    buffer_load_dwordx4 v[128:131], v15, s[36:39], s81 offen
    s_waitcnt vmcnt(11)
    s_nop 0
    v_mfma_f32_16x16x32_bf16 v[188:191], v[216:219], v[96:99], 0
    buffer_load_dwordx4 v[132:135], v15, s[36:39], s82 offen
    v_dot2_f32_bf16 v9, v96, v96, 0
    v_dot2_f32_bf16 v9, v97, v97, v9
    v_dot2_f32_bf16 v9, v98, v98, v9
    v_dot2_f32_bf16 v9, v99, v99, v9
    s_waitcnt vmcnt(10)
    s_nop 0
    v_mfma_f32_16x16x32_bf16 v[188:191], v[216:219], v[100:103], v[188:191]
    buffer_load_dwordx4 v[136:139], v15, s[36:39], s83 offen
    v_dot2_f32_bf16 v9, v100, v100, v9
    v_dot2_f32_bf16 v9, v101, v101, v9
    v_dot2_f32_bf16 v9, v102, v102, v9
    v_dot2_f32_bf16 v9, v103, v103, v9
    v_lshlrev_b32 v16, 16, v96
    v_and_b32 v17, 0xffff0000, v96
    v_lshlrev_b32 v18, 16, v97
    v_and_b32 v19, 0xffff0000, v97
    v_lshlrev_b32 v20, 16, v98
    v_and_b32 v21, 0xffff0000, v98
    v_lshlrev_b32 v22, 16, v99
    v_and_b32 v23, 0xffff0000, v99
    s_waitcnt vmcnt(10)
    s_nop 0
    v_mfma_f32_16x16x32_bf16 v[188:191], v[216:219], v[104:107], v[188:191]
    buffer_load_dwordx4 v[140:143], v15, s[36:39], s84 offen
    v_dot2_f32_bf16 v9, v104, v104, v9
    v_dot2_f32_bf16 v9, v105, v105, v9
    v_dot2_f32_bf16 v9, v106, v106, v9
    v_dot2_f32_bf16 v9, v107, v107, v9
    v_lshlrev_b32 v24, 16, v100
    v_and_b32 v25, 0xffff0000, v100
    v_lshlrev_b32 v26, 16, v101
    v_and_b32 v27, 0xffff0000, v101
    v_lshlrev_b32 v28, 16, v102
    v_and_b32 v29, 0xffff0000, v102
    v_lshlrev_b32 v30, 16, v103
    v_and_b32 v31, 0xffff0000, v103
    s_waitcnt vmcnt(10)
    s_nop 0
    v_mfma_f32_16x16x32_bf16 v[188:191], v[216:219], v[108:111], v[188:191]
    buffer_load_dwordx4 v[144:147], v15, s[36:39], s85 offen
    v_dot2_f32_bf16 v9, v108, v108, v9
    v_dot2_f32_bf16 v9, v109, v109, v9
    v_dot2_f32_bf16 v9, v110, v110, v9
    v_dot2_f32_bf16 v9, v111, v111, v9
    s_waitcnt vmcnt(10)
    s_nop 0
    v_mfma_f32_16x16x32_bf16 v[188:191], v[216:219], v[112:115], v[188:191]
    buffer_load_dwordx4 v[148:151], v15, s[36:39], s86 offen
    global_load_ushort v168, v170, s[6:7]
    global_load_ushort v169, v170, s[8:9]
    global_load_ushort v170, v170, s[18:19]
    v_dot2_f32_bf16 v9, v112, v112, v9
    v_dot2_f32_bf16 v9, v113, v113, v9
    v_dot2_f32_bf16 v9, v114, v114, v9
    v_dot2_f32_bf16 v9, v115, v115, v9
    s_waitcnt vmcnt(13)
    s_nop 0
    v_mfma_f32_16x16x32_bf16 v[188:191], v[216:219], v[116:119], v[188:191]
    s_add_u32 m0, s93, 36864
    s_mul_i32 s94, s80, 1792
    buffer_load_dwordx4 v196, s[60:63], s94 offen offset:0 lds
    v_dot2_f32_bf16 v9, v116, v116, v9
    v_dot2_f32_bf16 v9, v117, v117, v9
    v_dot2_f32_bf16 v9, v118, v118, v9
    v_dot2_f32_bf16 v9, v119, v119, v9
    s_waitcnt vmcnt(13)
    s_nop 0
    v_mfma_f32_16x16x32_bf16 v[188:191], v[216:219], v[120:123], v[188:191]
    buffer_load_dwordx4 v197, s[60:63], s94 offen offset:1024 lds
    v_dot2_f32_bf16 v9, v120, v120, v9
    v_dot2_f32_bf16 v9, v121, v121, v9
    v_dot2_f32_bf16 v9, v122, v122, v9
    v_dot2_f32_bf16 v9, v123, v123, v9
    v_lshlrev_b32 v32, 16, v104
    v_and_b32 v33, 0xffff0000, v104
    v_lshlrev_b32 v34, 16, v105
    v_add_f32_dpp v9, v9, v9 quad_perm:[1,0,3,2] row_mask:0xf bank_mask:0xf bound_ctrl:0
    v_add_f32_dpp v188, v188, v188 quad_perm:[1,0,3,2] row_mask:0xf bank_mask:0xf bound_ctrl:0
    v_and_b32 v35, 0xffff0000, v105
    v_add_f32_dpp v9, v9, v9 quad_perm:[2,3,0,1] row_mask:0xf bank_mask:0xf bound_ctrl:0
    v_add_f32_dpp v188, v188, v188 quad_perm:[2,3,0,1] row_mask:0xf bank_mask:0xf bound_ctrl:0
    v_lshlrev_b32_e64 v36, 16, v106
    v_add_f32_dpp v9, v9, v9 row_half_mirror row_mask:0xf bank_mask:0xf bound_ctrl:0
    v_add_f32_dpp v188, v188, v188 row_half_mirror row_mask:0xf bank_mask:0xf bound_ctrl:0
    v_and_b32 v37, 0xffff0000, v106
    v_mul_f32 v188, 991054117, v188
    v_mul_f32 v9, 991054117, v9
    v_fma_f32 v9, -v188, v188, v9
    v_max_f32_e64 v9, 0, v9
    v_cvt_pk_bf16_f32 v188, v188, v9
    v_and_b32 v9, 0xffff0000, v188
    v_add_f32 v9, 925353388, v9
    v_cvt_pk_bf16_f32 v9, v9, v9
    v_lshlrev_b32 v9, 16, v9
    v_sqrt_f32 v9, v9
    v_lshlrev_b32 v188, 16, v188
    v_cvt_pk_bf16_f32 v9, v9, v9
    v_lshlrev_b32 v9, 16, v9
    v_rcp_f32 v9, v9
    v_lshlrev_b32 v38, 16, v107
    v_and_b32 v39, 0xffff0000, v107
    v_mul_f32 v10, 1069066811, v9
    v_mul_f32 v11, -v188, v10
    s_waitcnt vmcnt(13)
    v_lshlrev_b32 v152, 16, v184
    v_and_b32 v153, 0xffff0000, v184
    v_lshlrev_b32 v154, 16, v185
    v_and_b32 v155, 0xffff0000, v185
    v_lshlrev_b32 v156, 16, v186
    v_and_b32 v157, 0xffff0000, v186
    v_lshlrev_b32_e64 v158, 16, v187
    v_and_b32 v159, 0xffff0000, v187
    v_pk_fma_f32 v[184:185], v[16:17], v[10:11], v[10:11] op_sel:[0,0,1] op_sel_hi:[1,0,1]
    v_pk_fma_f32 v[186:187], v[18:19], v[10:11], v[10:11] op_sel:[0,0,1] op_sel_hi:[1,0,1]
    v_pk_fma_f32 v[188:189], v[20:21], v[10:11], v[10:11] op_sel:[0,0,1] op_sel_hi:[1,0,1]
    v_pk_fma_f32 v[190:191], v[22:23], v[10:11], v[10:11] op_sel:[0,0,1] op_sel_hi:[1,0,1]
    v_cvt_pk_bf16_f32 v96, v184, v185
    v_cvt_pk_bf16_f32 v97, v186, v187
    v_cvt_pk_bf16_f32 v98, v188, v189
    v_cvt_pk_bf16_f32 v99, v190, v191
    ds_write_b128 v12, v[96:99] offset:0
    buffer_load_dwordx4 v198, s[60:63], s94 offen offset:2048 lds
    buffer_load_dwordx4 v199, s[60:63], s94 offen offset:3072 lds
    v_pk_fma_f32 v[24:25], v[24:25], v[10:11], v[10:11] op_sel:[0,0,1] op_sel_hi:[1,0,1]
    v_pk_fma_f32 v[26:27], v[26:27], v[10:11], v[10:11] op_sel:[0,0,1] op_sel_hi:[1,0,1]
    v_pk_fma_f32 v[28:29], v[28:29], v[10:11], v[10:11] op_sel:[0,0,1] op_sel_hi:[1,0,1]
    v_pk_fma_f32 v[30:31], v[30:31], v[10:11], v[10:11] op_sel:[0,0,1] op_sel_hi:[1,0,1]
    v_cvt_pk_bf16_f32 v100, v24, v25
    v_cvt_pk_bf16_f32 v101, v26, v27
    v_cvt_pk_bf16_f32 v102, v28, v29
    v_cvt_pk_bf16_f32 v103, v30, v31
    ds_write_b128 v12, v[100:103] offset:8192
    s_add_u32 m0, s93, 53248
    s_mul_i32 s94, s81, 1792
    buffer_load_dwordx4 v196, s[60:63], s94 offen offset:0 lds
    buffer_load_dwordx4 v197, s[60:63], s94 offen offset:1024 lds
    v_pk_fma_f32 v[32:33], v[32:33], v[10:11], v[10:11] op_sel:[0,0,1] op_sel_hi:[1,0,1]
    v_pk_fma_f32 v[34:35], v[34:35], v[10:11], v[10:11] op_sel:[0,0,1] op_sel_hi:[1,0,1]
    v_pk_fma_f32 v[36:37], v[36:37], v[10:11], v[10:11] op_sel:[0,0,1] op_sel_hi:[1,0,1]
    v_pk_fma_f32 v[38:39], v[38:39], v[10:11], v[10:11] op_sel:[0,0,1] op_sel_hi:[1,0,1]
    v_cvt_pk_bf16_f32 v104, v32, v33
    v_cvt_pk_bf16_f32 v105, v34, v35
    v_cvt_pk_bf16_f32 v106, v36, v37
    v_cvt_pk_bf16_f32 v107, v38, v39
    ds_write_b128 v12, v[104:107] offset:16384
    buffer_load_dwordx4 v198, s[60:63], s94 offen offset:2048 lds
    buffer_load_dwordx4 v199, s[60:63], s94 offen offset:3072 lds
    v_pk_mul_f32 v[16:17], v[16:17], s[28:29]
    v_pk_mul_f32 v[18:19], v[18:19], s[28:29]
    v_pk_mul_f32 v[20:21], v[20:21], s[28:29]
    v_pk_mul_f32 v[22:23], v[22:23], s[28:29]
    v_pk_fma_f32 v[16:17], v[184:185], v[152:153], v[16:17]
    v_pk_fma_f32 v[18:19], v[186:187], v[154:155], v[18:19]
    v_pk_fma_f32 v[20:21], v[188:189], v[156:157], v[20:21]
    v_pk_fma_f32 v[22:23], v[190:191], v[158:159], v[22:23]
    v_cvt_pk_bf16_f32 v184, v16, v17
    v_cvt_pk_bf16_f32 v185, v18, v19
    v_cvt_pk_bf16_f32 v186, v20, v21
    v_cvt_pk_bf16_f32 v187, v22, v23
    ds_write_b128 v13, v[184:187] offset:0
    s_waitcnt vmcnt(18)
    v_mov_b32 v173, v172
    v_lshl_or_b32 v172, v172, 16, v172
    s_waitcnt vmcnt(17)
    v_mov_b32 v177, v176
    v_lshl_or_b32 v176, v176, 16, v176
    v_mfma_f32_32x32x16_bf16 v[48:63], v[172:175], v[180:183], 0
    v_nop_e64
    v_mfma_f32_32x32x16_bf16 v[80:95], v[176:179], v[180:183], 0
    v_mfma_f32_16x16x32_bf16 v[188:191], v[216:219], v[124:127], 0
    s_add_u32 m0, s93, 69632
    s_mul_i32 s94, s82, 1792
    buffer_load_dwordx4 v196, s[60:63], s94 offen offset:0 lds
    v_dot2_f32_bf16 v9, v124, v124, 0
    v_dot2_f32_bf16 v9, v125, v125, v9
    v_dot2_f32_bf16 v9, v126, v126, v9
    v_dot2_f32_bf16 v9, v127, v127, v9
    s_waitcnt vmcnt(17)
    s_nop 0
    v_mfma_f32_16x16x32_bf16 v[188:191], v[216:219], v[128:131], v[188:191]
    buffer_load_dwordx4 v197, s[60:63], s94 offen offset:1024 lds
    v_dot2_f32_bf16 v9, v128, v128, v9
    v_dot2_f32_bf16 v9, v129, v129, v9
    v_dot2_f32_bf16 v9, v130, v130, v9
    v_dot2_f32_bf16 v9, v131, v131, v9
    v_lshlrev_b32 v16, 16, v124
    v_and_b32 v17, 0xffff0000, v124
    v_lshlrev_b32 v18, 16, v125
    v_and_b32 v19, 0xffff0000, v125
    v_lshlrev_b32 v20, 16, v126
    v_and_b32 v21, 0xffff0000, v126
    v_lshlrev_b32 v22, 16, v127
    v_and_b32 v23, 0xffff0000, v127
    s_waitcnt vmcnt(17)
    s_nop 0
    v_mfma_f32_16x16x32_bf16 v[188:191], v[216:219], v[132:135], v[188:191]
    buffer_load_dwordx4 v198, s[60:63], s94 offen offset:2048 lds
    v_dot2_f32_bf16 v9, v132, v132, v9
    v_dot2_f32_bf16 v9, v133, v133, v9
    v_dot2_f32_bf16 v9, v134, v134, v9
    v_dot2_f32_bf16 v9, v135, v135, v9
    v_lshlrev_b32 v24, 16, v128
    v_and_b32 v25, 0xffff0000, v128
    v_lshlrev_b32 v26, 16, v129
    v_and_b32 v27, 0xffff0000, v129
    v_lshlrev_b32 v28, 16, v130
    v_and_b32 v29, 0xffff0000, v130
    v_lshlrev_b32 v30, 16, v131
    v_and_b32 v31, 0xffff0000, v131
    s_waitcnt vmcnt(17)
    s_nop 0
    v_mfma_f32_16x16x32_bf16 v[188:191], v[216:219], v[136:139], v[188:191]
    buffer_load_dwordx4 v199, s[60:63], s94 offen offset:3072 lds
    v_dot2_f32_bf16 v9, v136, v136, v9
    v_dot2_f32_bf16 v9, v137, v137, v9
    v_dot2_f32_bf16 v9, v138, v138, v9
    v_dot2_f32_bf16 v9, v139, v139, v9
    s_waitcnt vmcnt(17)
    s_nop 0
    v_mfma_f32_16x16x32_bf16 v[188:191], v[216:219], v[140:143], v[188:191]
    s_add_u32 m0, s93, 86016
    s_mul_i32 s94, s83, 1792
    buffer_load_dwordx4 v196, s[60:63], s94 offen offset:0 lds
    v_dot2_f32_bf16 v9, v140, v140, v9
    v_dot2_f32_bf16 v9, v141, v141, v9
    v_dot2_f32_bf16 v9, v142, v142, v9
    v_dot2_f32_bf16 v9, v143, v143, v9
    s_waitcnt vmcnt(17)
    s_nop 0
    v_mfma_f32_16x16x32_bf16 v[188:191], v[216:219], v[144:147], v[188:191]
    buffer_load_dwordx4 v197, s[60:63], s94 offen offset:1024 lds
    v_dot2_f32_bf16 v9, v144, v144, v9
    v_dot2_f32_bf16 v9, v145, v145, v9
    v_dot2_f32_bf16 v9, v146, v146, v9
    v_dot2_f32_bf16 v9, v147, v147, v9
    s_waitcnt vmcnt(17)
    s_nop 0
    v_mfma_f32_16x16x32_bf16 v[188:191], v[216:219], v[148:151], v[188:191]
    buffer_load_dwordx4 v198, s[60:63], s94 offen offset:2048 lds
    buffer_load_dwordx4 v199, s[60:63], s94 offen offset:3072 lds
    v_dot2_f32_bf16 v9, v148, v148, v9
    v_dot2_f32_bf16 v9, v149, v149, v9
    v_dot2_f32_bf16 v9, v150, v150, v9
    v_dot2_f32_bf16 v9, v151, v151, v9
    v_lshlrev_b32 v32, 16, v132
    v_and_b32 v33, 0xffff0000, v132
    v_lshlrev_b32 v34, 16, v133
    v_add_f32_dpp v9, v9, v9 quad_perm:[1,0,3,2] row_mask:0xf bank_mask:0xf bound_ctrl:0
    v_add_f32_dpp v188, v188, v188 quad_perm:[1,0,3,2] row_mask:0xf bank_mask:0xf bound_ctrl:0
    v_and_b32 v35, 0xffff0000, v133
    v_add_f32_dpp v9, v9, v9 quad_perm:[2,3,0,1] row_mask:0xf bank_mask:0xf bound_ctrl:0
    v_add_f32_dpp v188, v188, v188 quad_perm:[2,3,0,1] row_mask:0xf bank_mask:0xf bound_ctrl:0
    v_lshlrev_b32_e64 v36, 16, v134
    v_add_f32_dpp v9, v9, v9 row_half_mirror row_mask:0xf bank_mask:0xf bound_ctrl:0
    v_add_f32_dpp v188, v188, v188 row_half_mirror row_mask:0xf bank_mask:0xf bound_ctrl:0
    v_and_b32 v37, 0xffff0000, v134
    v_mul_f32 v188, 991054117, v188
    v_mul_f32 v9, 991054117, v9
    v_fma_f32 v9, -v188, v188, v9
    v_max_f32_e64 v9, 0, v9
    v_cvt_pk_bf16_f32 v188, v188, v9
    v_and_b32 v9, 0xffff0000, v188
    v_add_f32 v9, 925353388, v9
    v_cvt_pk_bf16_f32 v9, v9, v9
    v_lshlrev_b32 v9, 16, v9
    v_sqrt_f32 v9, v9
    v_lshlrev_b32 v188, 16, v188
    v_cvt_pk_bf16_f32 v9, v9, v9
    v_lshlrev_b32 v9, 16, v9
    v_rcp_f32 v9, v9
    v_lshlrev_b32 v38, 16, v135
    v_and_b32 v39, 0xffff0000, v135
    v_mul_f32 v14, 1069066811, v9
    v_mul_f32 v15, -v188, v14
    v_pk_fma_f32 v[184:185], v[16:17], v[14:15], v[14:15] op_sel:[0,0,1] op_sel_hi:[1,0,1]
    v_pk_fma_f32 v[186:187], v[18:19], v[14:15], v[14:15] op_sel:[0,0,1] op_sel_hi:[1,0,1]
    v_pk_fma_f32 v[188:189], v[20:21], v[14:15], v[14:15] op_sel:[0,0,1] op_sel_hi:[1,0,1]
    v_pk_fma_f32 v[190:191], v[22:23], v[14:15], v[14:15] op_sel:[0,0,1] op_sel_hi:[1,0,1]
    v_cvt_pk_bf16_f32 v124, v184, v185
    v_cvt_pk_bf16_f32 v125, v186, v187
    v_cvt_pk_bf16_f32 v126, v188, v189
    v_cvt_pk_bf16_f32 v127, v190, v191
    ds_write_b128 v12, v[124:127] offset:2048
    s_add_u32 m0, s93, 102400
    s_mul_i32 s94, s84, 1792
    buffer_load_dwordx4 v196, s[60:63], s94 offen offset:0 lds
    v_pk_fma_f32 v[24:25], v[24:25], v[14:15], v[14:15] op_sel:[0,0,1] op_sel_hi:[1,0,1]
    v_pk_fma_f32 v[26:27], v[26:27], v[14:15], v[14:15] op_sel:[0,0,1] op_sel_hi:[1,0,1]
    v_pk_fma_f32 v[28:29], v[28:29], v[14:15], v[14:15] op_sel:[0,0,1] op_sel_hi:[1,0,1]
    v_pk_fma_f32 v[30:31], v[30:31], v[14:15], v[14:15] op_sel:[0,0,1] op_sel_hi:[1,0,1]
    v_cvt_pk_bf16_f32 v128, v24, v25
    v_cvt_pk_bf16_f32 v129, v26, v27
    v_cvt_pk_bf16_f32 v130, v28, v29
    v_cvt_pk_bf16_f32 v131, v30, v31
    ds_write_b128 v12, v[128:131] offset:10240
    buffer_load_dwordx4 v197, s[60:63], s94 offen offset:1024 lds
    v_pk_fma_f32 v[32:33], v[32:33], v[14:15], v[14:15] op_sel:[0,0,1] op_sel_hi:[1,0,1]
    v_pk_fma_f32 v[34:35], v[34:35], v[14:15], v[14:15] op_sel:[0,0,1] op_sel_hi:[1,0,1]
    v_pk_fma_f32 v[36:37], v[36:37], v[14:15], v[14:15] op_sel:[0,0,1] op_sel_hi:[1,0,1]
    v_pk_fma_f32 v[38:39], v[38:39], v[14:15], v[14:15] op_sel:[0,0,1] op_sel_hi:[1,0,1]
    v_cvt_pk_bf16_f32 v132, v32, v33
    v_cvt_pk_bf16_f32 v133, v34, v35
    v_cvt_pk_bf16_f32 v134, v36, v37
    v_cvt_pk_bf16_f32 v135, v38, v39
    s_waitcnt vmcnt(14) lgkmcnt(1)
    s_barrier
    ds_read_b64_tr_b16 a[224:225], v212 offset:32768
    ds_read_b64_tr_b16 a[226:227], v212 offset:33280
    ds_read_b128 a[4:7], v208 offset:4096
    ds_read_b128 a[0:3], v208 offset:0
    ds_read_b64_tr_b16 a[228:229], v212 offset:34816
    ds_read_b64_tr_b16 a[230:231], v212 offset:35328
    ds_read_b128 a[12:15], v209 offset:4096
    ds_read_b128 a[8:11], v209 offset:0
    ds_read_b64_tr_b16 a[232:233], v212 offset:36864
    ds_read_b64_tr_b16 a[234:235], v212 offset:37376
    ds_read_b128 a[20:23], v210 offset:4096
    ds_read_b128 a[16:19], v210 offset:0
    ds_read_b64_tr_b16 a[236:237], v212 offset:38912
    ds_read_b64_tr_b16 a[238:239], v212 offset:39424
    ds_read_b128 a[28:31], v211 offset:4096
    ds_read_b128 a[24:27], v211 offset:0
    ds_write_b128 v12, v[132:135] offset:18432
    buffer_load_dwordx4 v198, s[60:63], s94 offen offset:2048 lds
    buffer_load_dwordx4 v199, s[60:63], s94 offen offset:3072 lds
    v_pk_mul_f32 v[16:17], v[16:17], s[28:29]
    v_pk_mul_f32 v[18:19], v[18:19], s[28:29]
    v_pk_mul_f32 v[20:21], v[20:21], s[28:29]
    v_pk_mul_f32 v[22:23], v[22:23], s[28:29]
    v_pk_fma_f32 v[16:17], v[184:185], v[152:153], v[16:17]
    v_pk_fma_f32 v[18:19], v[186:187], v[154:155], v[18:19]
    v_pk_fma_f32 v[20:21], v[188:189], v[156:157], v[20:21]
    v_pk_fma_f32 v[22:23], v[190:191], v[158:159], v[22:23]
    v_cvt_pk_bf16_f32 v184, v16, v17
    v_cvt_pk_bf16_f32 v185, v18, v19
    v_cvt_pk_bf16_f32 v186, v20, v21
    v_cvt_pk_bf16_f32 v187, v22, v23
    ds_write_b128 v13, v[184:187] offset:1024
    s_waitcnt vmcnt(12) lgkmcnt(2)
    s_barrier
    v_mfma_f32_32x32x16_bf16 v[64:79], a[224:227], a[4:7], v[48:63]
    ds_read_b64_tr_b16 a[240:241], v212 offset:49152
    ds_read_b64_tr_b16 a[242:243], v212 offset:49664
    ds_read_b128 a[36:39], v208 offset:12288
    ds_read_b128 a[32:35], v208 offset:8192
    v_lshlrev_b32 v24, 16, v108
    v_and_b32 v25, 0xffff0000, v108
    v_lshlrev_b32 v26, 16, v109
    v_and_b32 v27, 0xffff0000, v109
    v_lshlrev_b32 v28, 16, v110
    v_and_b32 v29, 0xffff0000, v110
    v_lshlrev_b32 v30, 16, v111
    v_and_b32 v31, 0xffff0000, v111
    v_fma_f32 v24, v24, v10, v11
    v_mfma_f32_32x32x16_bf16 v[48:63], a[224:227], a[0:3], v[48:63]
    ds_read_b64_tr_b16 a[244:245], v212 offset:51200
    ds_read_b64_tr_b16 a[246:247], v212 offset:51712
    ds_read_b128 a[44:47], v209 offset:12288
    s_add_u32 m0, s93, 118784
    s_mul_i32 s94, s85, 1792
    buffer_load_dwordx4 v196, s[60:63], s94 offen offset:0 lds
    v_fma_f32 v25, v25, v10, v11
    v_fma_f32 v26, v26, v10, v11
    v_fma_f32 v27, v27, v10, v11
    v_fma_f32 v28, v28, v10, v11
    v_fma_f32 v29, v29, v10, v11
    v_mfma_f32_32x32x16_bf16 v[64:79], a[228:231], a[12:15], v[64:79]
    ds_read_b128 a[40:43], v209 offset:8192
    ds_read_b64_tr_b16 a[248:249], v212 offset:53248
    ds_read_b64_tr_b16 a[250:251], v212 offset:53760
    ds_read_b128 a[52:55], v210 offset:12288
    v_fma_f32 v30, v30, v10, v11
    v_fma_f32 v31, v31, v10, v11
    v_cvt_pk_bf16_f32 v108, v24, v25
    v_cvt_pk_bf16_f32 v109, v26, v27
    v_cvt_pk_bf16_f32 v110, v28, v29
    v_cvt_pk_bf16_f32 v111, v30, v31
    v_lshlrev_b32_e64 v32, 16, v136
    v_and_b32 v33, 0xffff0000, v136
    v_mfma_f32_32x32x16_bf16 v[48:63], a[228:231], a[8:11], v[48:63]
    ds_read_b128 a[48:51], v210 offset:8192
    ds_read_b64_tr_b16 a[252:253], v212 offset:55296
    ds_read_b64_tr_b16 a[254:255], v212 offset:55808
    v_lshlrev_b32 v34, 16, v137
    v_and_b32 v35, 0xffff0000, v137
    v_lshlrev_b32 v36, 16, v138
    v_and_b32 v37, 0xffff0000, v138
    v_lshlrev_b32_e64 v38, 16, v139
    v_and_b32 v39, 0xffff0000, v139
    v_fma_f32 v32, v32, v14, v15
    v_fma_f32 v33, v33, v14, v15
    v_fma_f32 v34, v34, v14, v15
    v_fma_f32 v35, v35, v14, v15
    v_mfma_f32_32x32x16_bf16 v[64:79], a[232:235], a[20:23], v[64:79]
    ds_read_b128 a[60:63], v211 offset:12288
    ds_read_b128 a[56:59], v211 offset:8192
    buffer_load_dwordx4 v197, s[60:63], s94 offen offset:1024 lds
    v_fma_f32 v36, v36, v14, v15
    v_fma_f32 v37, v37, v14, v15
    v_fma_f32 v38, v38, v14, v15
    v_fma_f32 v39, v39, v14, v15
    v_cvt_pk_bf16_f32 v136, v32, v33
    v_cvt_pk_bf16_f32 v137, v34, v35
    v_cvt_pk_bf16_f32 v138, v36, v37
    v_cvt_pk_bf16_f32 v139, v38, v39
    v_mfma_f32_32x32x16_bf16 v[48:63], a[232:235], a[16:19], v[48:63]
    buffer_load_dwordx4 v198, s[60:63], s94 offen offset:2048 lds
    ds_write_b128 v12, v[108:111] offset:24576
    v_lshlrev_b32_e64 v24, 16, v112
    v_mfma_f32_32x32x16_bf16 v[64:79], a[236:239], a[28:31], v[64:79]
    buffer_load_dwordx4 v199, s[60:63], s94 offen offset:3072 lds
    ds_write_b128 v12, v[136:139] offset:26624
    v_mfma_f32_32x32x16_bf16 v[48:63], a[236:239], a[24:27], v[48:63]
    s_waitcnt vmcnt(12) lgkmcnt(2)
    s_barrier
    s_add_u32 m0, s93, 36864
    s_mul_i32 s94, s86, 1792
    buffer_load_dwordx4 v196, s[60:63], s94 offen offset:0 lds
    v_and_b32 v25, 0xffff0000, v112
    v_lshlrev_b32 v26, 16, v113
    v_and_b32 v27, 0xffff0000, v113
    v_lshlrev_b32 v28, 16, v114
    v_mfma_f32_32x32x16_bf16 v[64:79], a[240:243], a[36:39], v[64:79]
    ds_read_b64_tr_b16 a[224:225], v213 offset:0
    ds_read_b64_tr_b16 a[226:227], v213 offset:512
    ds_read_b128 a[68:71], v208 offset:20480
    ds_read_b128 a[64:67], v208 offset:16384
    v_and_b32 v29, 0xffff0000, v114
    v_lshlrev_b32_e64 v30, 16, v115
    v_and_b32 v31, 0xffff0000, v115
    v_fma_f32 v24, v24, v10, v11
    v_fma_f32 v25, v25, v10, v11
    v_fma_f32 v26, v26, v10, v11
    v_fma_f32 v27, v27, v10, v11
    v_fma_f32 v28, v28, v10, v11
    v_mfma_f32_32x32x16_bf16 v[48:63], a[240:243], a[32:35], v[48:63]
    ds_read_b64_tr_b16 a[228:229], v213 offset:2048
    ds_read_b64_tr_b16 a[230:231], v213 offset:2560
    ds_read_b128 a[76:79], v209 offset:20480
    buffer_load_dwordx4 v197, s[60:63], s94 offen offset:1024 lds
    v_fma_f32 v29, v29, v10, v11
    v_fma_f32 v30, v30, v10, v11
    v_fma_f32 v31, v31, v10, v11
    v_cvt_pk_bf16_f32 v112, v24, v25
    v_cvt_pk_bf16_f32 v113, v26, v27
    v_mfma_f32_32x32x16_bf16 v[64:79], a[244:247], a[44:47], v[64:79]
    ds_read_b128 a[72:75], v209 offset:16384
    ds_read_b64_tr_b16 a[232:233], v213 offset:4096
    ds_read_b64_tr_b16 a[234:235], v213 offset:4608
    ds_read_b128 a[84:87], v210 offset:20480
    v_cvt_pk_bf16_f32 v114, v28, v29
    v_cvt_pk_bf16_f32 v115, v30, v31
    v_lshlrev_b32 v32, 16, v140
    v_and_b32 v33, 0xffff0000, v140
    v_lshlrev_b32 v34, 16, v141
    v_and_b32 v35, 0xffff0000, v141
    v_lshlrev_b32_e64 v36, 16, v142
    v_and_b32 v37, 0xffff0000, v142
    v_mfma_f32_32x32x16_bf16 v[48:63], a[244:247], a[40:43], v[48:63]
    ds_read_b128 a[80:83], v210 offset:16384
    ds_read_b64_tr_b16 a[236:237], v213 offset:6144
    ds_read_b64_tr_b16 a[238:239], v213 offset:6656
    v_lshlrev_b32_e64 v38, 16, v143
    v_and_b32 v39, 0xffff0000, v143
    v_fma_f32 v32, v32, v14, v15
    v_fma_f32 v33, v33, v14, v15
    v_fma_f32 v34, v34, v14, v15
    v_fma_f32 v35, v35, v14, v15
    v_fma_f32 v36, v36, v14, v15
    v_fma_f32 v37, v37, v14, v15
    v_mfma_f32_32x32x16_bf16 v[64:79], a[248:251], a[52:55], v[64:79]
    ds_read_b128 a[92:95], v211 offset:20480
    ds_read_b128 a[88:91], v211 offset:16384
    buffer_load_dwordx4 v198, s[60:63], s94 offen offset:2048 lds
    v_fma_f32 v38, v38, v14, v15
    v_fma_f32 v39, v39, v14, v15
    v_cvt_pk_bf16_f32 v140, v32, v33
    v_cvt_pk_bf16_f32 v141, v34, v35
    v_cvt_pk_bf16_f32 v142, v36, v37
    v_cvt_pk_bf16_f32 v143, v38, v39
    v_lshlrev_b32_e64 v24, 16, v116
    v_mfma_f32_32x32x16_bf16 v[48:63], a[248:251], a[48:51], v[48:63]
    buffer_load_dwordx4 v199, s[60:63], s94 offen offset:3072 lds
    ds_write_b128 v12, v[112:115] offset:32768
    v_mfma_f32_32x32x16_bf16 v[64:79], a[252:255], a[60:63], v[64:79]
    s_add_u32 m0, s93, 53248
    v_nop_e64
    buffer_load_dwordx4 v192, s[40:43], s80 offen offset:0 lds
    ds_write_b128 v12, v[140:143] offset:34816
    v_mfma_f32_32x32x16_bf16 v[48:63], a[252:255], a[56:59], v[48:63]
    s_waitcnt vmcnt(13) lgkmcnt(2)
    s_barrier
    buffer_load_dwordx4 v193, s[44:47], s80 offen offset:1024 lds
    v_and_b32 v25, 0xffff0000, v116
    v_lshlrev_b32 v26, 16, v117
    v_and_b32 v27, 0xffff0000, v117
    v_lshlrev_b32 v28, 16, v118
    v_and_b32 v29, 0xffff0000, v118
    v_mfma_f32_32x32x16_bf16 v[64:79], a[224:227], a[68:71], v[64:79]
    ds_read_b64_tr_b16 a[240:241], v213 offset:16384
    ds_read_b64_tr_b16 a[242:243], v213 offset:16896
    ds_read_b128 a[100:103], v208 offset:28672
    ds_read_b128 a[96:99], v208 offset:24576
    s_mov_b64 s[36:37], s[32:33]
    s_mov_b32 s38, 256
    s_mov_b32 s39, 0x20000
    v_lshlrev_b32 v30, 16, v119
    v_and_b32 v31, 0xffff0000, v119
    v_fma_f32 v24, v24, v10, v11
    v_fma_f32 v25, v25, v10, v11
    v_fma_f32 v26, v26, v10, v11
    v_fma_f32 v27, v27, v10, v11
    v_mfma_f32_32x32x16_bf16 v[48:63], a[224:227], a[64:67], v[48:63]
    ds_read_b64_tr_b16 a[244:245], v213 offset:18432
    ds_read_b64_tr_b16 a[246:247], v213 offset:18944
    ds_read_b128 a[108:111], v209 offset:28672
    buffer_load_dwordx4 v194, s[40:43], s80 offen offset:2048 lds
    v_fma_f32 v28, v28, v10, v11
    v_fma_f32 v29, v29, v10, v11
    v_fma_f32 v30, v30, v10, v11
    v_fma_f32 v31, v31, v10, v11
    v_cvt_pk_bf16_f32 v116, v24, v25
    v_mfma_f32_32x32x16_bf16 v[64:79], a[228:231], a[76:79], v[64:79]
    ds_read_b128 a[104:107], v209 offset:24576
    ds_read_b64_tr_b16 a[248:249], v213 offset:20480
    ds_read_b64_tr_b16 a[250:251], v213 offset:20992
    ds_read_b128 a[116:119], v210 offset:28672
    v_cvt_pk_bf16_f32 v117, v26, v27
    v_cvt_pk_bf16_f32 v118, v28, v29
    v_cvt_pk_bf16_f32 v119, v30, v31
    v_lshlrev_b32 v32, 16, v144
    v_and_b32 v33, 0xffff0000, v144
    v_lshlrev_b32 v34, 16, v145
    v_and_b32 v35, 0xffff0000, v145
    v_lshlrev_b32_e64 v36, 16, v146
    v_mfma_f32_32x32x16_bf16 v[48:63], a[228:231], a[72:75], v[48:63]
    ds_read_b128 a[112:115], v210 offset:24576
    ds_read_b64_tr_b16 a[252:253], v213 offset:22528
    ds_read_b64_tr_b16 a[254:255], v213 offset:23040
    v_and_b32 v37, 0xffff0000, v146
    v_lshlrev_b32_e64 v38, 16, v147
    v_and_b32 v39, 0xffff0000, v147
    v_fma_f32 v32, v32, v14, v15
    v_fma_f32 v33, v33, v14, v15
    v_fma_f32 v34, v34, v14, v15
    v_fma_f32 v35, v35, v14, v15
    v_fma_f32 v36, v36, v14, v15
    v_mfma_f32_32x32x16_bf16 v[64:79], a[232:235], a[84:87], v[64:79]
    ds_read_b128 a[124:127], v211 offset:28672
    ds_read_b128 a[120:123], v211 offset:24576
    buffer_load_dwordx4 v195, s[44:47], s80 offen offset:3072 lds
    v_fma_f32 v37, v37, v14, v15
L_page1:
    s_cbranch_execz L_back0
    s_nop 0
    v_fma_f32 v38, v38, v14, v15
    v_fma_f32 v39, v39, v14, v15
    v_cvt_pk_bf16_f32 v144, v32, v33
    v_cvt_pk_bf16_f32 v145, v34, v35
    v_cvt_pk_bf16_f32 v146, v36, v37
    v_cvt_pk_bf16_f32 v147, v38, v39
    v_mfma_f32_32x32x16_bf16 v[48:63], a[232:235], a[80:83], v[48:63]
    s_add_u32 m0, s93, 69632
    v_nop_e64
    buffer_load_dwordx4 v192, s[40:43], s81 offen offset:0 lds
    ds_write_b128 v12, v[116:119] offset:40960
    v_mfma_f32_32x32x16_bf16 v[64:79], a[236:239], a[92:95], v[64:79]
    buffer_load_dwordx4 v193, s[44:47], s81 offen offset:1024 lds
    ds_write_b128 v12, v[144:147] offset:43008
    v_mfma_f32_32x32x16_bf16 v[48:63], a[236:239], a[88:91], v[48:63]
    s_waitcnt vmcnt(14) lgkmcnt(2)
    s_barrier
    buffer_load_dwordx4 v194, s[40:43], s81 offen offset:2048 lds
    v_lshlrev_b32 v24, 16, v120
    v_and_b32 v25, 0xffff0000, v120
    v_lshlrev_b32 v26, 16, v121
    v_and_b32 v27, 0xffff0000, v121
    v_lshlrev_b32_e64 v28, 16, v122
    v_mfma_f32_32x32x16_bf16 v[64:79], a[240:243], a[100:103], v[64:79]
    ds_read_b64_tr_b16 a[224:225], v213 offset:32768
    ds_read_b64_tr_b16 a[226:227], v213 offset:33280
    ds_read_b128 a[132:135], v208 offset:36864
    ds_read_b128 a[128:131], v208 offset:32768
    v_and_b32 v29, 0xffff0000, v122
    v_lshlrev_b32_e64 v30, 16, v123
    v_and_b32 v31, 0xffff0000, v123
    v_fma_f32 v24, v24, v10, v11
    v_fma_f32 v25, v25, v10, v11
    v_fma_f32 v26, v26, v10, v11
    v_fma_f32 v27, v27, v10, v11
    v_fma_f32 v28, v28, v10, v11
    v_mfma_f32_32x32x16_bf16 v[48:63], a[240:243], a[96:99], v[48:63]
    ds_read_b64_tr_b16 a[228:229], v213 offset:34816
    ds_read_b64_tr_b16 a[230:231], v213 offset:35328
    ds_read_b128 a[140:143], v209 offset:36864
    buffer_load_dwordx4 v195, s[44:47], s81 offen offset:3072 lds
    v_fma_f32 v29, v29, v10, v11
    v_fma_f32 v30, v30, v10, v11
    v_fma_f32 v31, v31, v10, v11
    v_cvt_pk_bf16_f32 v120, v24, v25
    v_cvt_pk_bf16_f32 v121, v26, v27
    v_mfma_f32_32x32x16_bf16 v[64:79], a[244:247], a[108:111], v[64:79]
    ds_read_b128 a[136:139], v209 offset:32768
    ds_read_b64_tr_b16 a[232:233], v213 offset:36864
    ds_read_b64_tr_b16 a[234:235], v213 offset:37376
    ds_read_b128 a[148:151], v210 offset:36864
    v_cvt_pk_bf16_f32 v122, v28, v29
    v_cvt_pk_bf16_f32 v123, v30, v31
    v_lshlrev_b32 v32, 16, v148
    v_and_b32 v33, 0xffff0000, v148
    v_lshlrev_b32 v34, 16, v149
    v_and_b32 v35, 0xffff0000, v149
    v_lshlrev_b32_e64 v36, 16, v150
    v_and_b32 v37, 0xffff0000, v150
    v_mfma_f32_32x32x16_bf16 v[48:63], a[244:247], a[104:107], v[48:63]
    ds_read_b128 a[144:147], v210 offset:32768
    ds_read_b64_tr_b16 a[236:237], v213 offset:38912
    ds_read_b64_tr_b16 a[238:239], v213 offset:39424
    v_lshlrev_b32_e64 v38, 16, v151
    v_and_b32 v39, 0xffff0000, v151
    v_fma_f32 v32, v32, v14, v15
    v_fma_f32 v33, v33, v14, v15
    v_fma_f32 v34, v34, v14, v15
    v_fma_f32 v35, v35, v14, v15
    v_fma_f32 v36, v36, v14, v15
    v_fma_f32 v37, v37, v14, v15
    v_mfma_f32_32x32x16_bf16 v[64:79], a[248:251], a[116:119], v[64:79]
    ds_read_b128 a[156:159], v211 offset:36864
    ds_read_b128 a[152:155], v211 offset:32768
    s_add_u32 m0, s93, 86016
    v_nop_e64
    buffer_load_dwordx4 v192, s[40:43], s82 offen offset:0 lds
    v_fma_f32 v38, v38, v14, v15
    v_fma_f32 v39, v39, v14, v15
    v_cvt_pk_bf16_f32 v148, v32, v33
    v_cvt_pk_bf16_f32 v149, v34, v35
    v_cvt_pk_bf16_f32 v150, v36, v37
    v_cvt_pk_bf16_f32 v151, v38, v39
    v_mfma_f32_32x32x16_bf16 v[48:63], a[248:251], a[112:115], v[48:63]
    buffer_load_dwordx4 v193, s[44:47], s82 offen offset:1024 lds
    ds_write_b128 v12, v[120:123] offset:49152
    v_mfma_f32_32x32x16_bf16 v[64:79], a[252:255], a[124:127], v[64:79]
    buffer_load_dwordx4 v194, s[40:43], s82 offen offset:2048 lds
    ds_write_b128 v12, v[148:151] offset:51200
    v_mfma_f32_32x32x16_bf16 v[48:63], a[252:255], a[120:123], v[48:63]
    s_waitcnt vmcnt(15) lgkmcnt(2)
    s_barrier
    buffer_load_dwordx4 v195, s[44:47], s82 offen offset:3072 lds
    v_mfma_f32_32x32x16_bf16 v[64:79], a[224:227], a[132:135], v[64:79]
    ds_read_b64_tr_b16 a[240:241], v213 offset:49152
    ds_read_b64_tr_b16 a[242:243], v213 offset:49664
    ds_read_b128 a[164:167], v208 offset:45056
    ds_read_b128 a[160:163], v208 offset:40960
    s_mov_b64 s[76:77], s[34:35]
    s_nop 0
    s_mov_b32 s78, 16777216
    v_mfma_f32_32x32x16_bf16 v[48:63], a[224:227], a[128:131], v[48:63]
    ds_read_b64_tr_b16 a[244:245], v213 offset:51200
    ds_read_b64_tr_b16 a[246:247], v213 offset:51712
    ds_read_b128 a[172:175], v209 offset:45056
    s_mov_b32 s79, 0x20000
    s_and_b32 s98, s90, 1
    s_lshr_b32 s99, s90, 1
    s_and_b32 s101, s92, 15
    v_mfma_f32_32x32x16_bf16 v[64:79], a[228:231], a[140:143], v[64:79]
    ds_read_b128 a[168:171], v209 offset:40960
    ds_read_b64_tr_b16 a[248:249], v213 offset:53248
    ds_read_b64_tr_b16 a[250:251], v213 offset:53760
    ds_read_b128 a[180:183], v210 offset:45056
    s_lshl_b32 s101, s101, 6
    s_add_u32 s101, s101, s98
    s_lshl_b32 s101, s101, 12
    v_mfma_f32_32x32x16_bf16 v[48:63], a[228:231], a[136:139], v[48:63]
    ds_read_b128 a[176:179], v210 offset:40960
    ds_read_b64_tr_b16 a[252:253], v213 offset:55296
    ds_read_b64_tr_b16 a[254:255], v213 offset:55808
    s_lshl_b32 s23, s99, 14
    s_add_u32 s9, s101, 2097152
    s_lshl_b32 s6, s87, 8
    s_add_u32 s6, s6, s9
    v_mfma_f32_32x32x16_bf16 v[64:79], a[232:235], a[148:151], v[64:79]
    ds_read_b128 a[188:191], v211 offset:45056
    ds_read_b128 a[184:187], v211 offset:40960
    s_add_u32 m0, s93, 102400
    s_nop 0
    buffer_load_dwordx4 v192, s[40:43], s83 offen offset:0 lds
    v_mfma_f32_32x32x16_bf16 v[48:63], a[232:235], a[144:147], v[48:63]
    buffer_load_dwordx4 v193, s[44:47], s83 offen offset:1024 lds
    s_add_u32 s6, s6, s23
    s_add_u32 s10, s101, 6291456
    v_mfma_f32_32x32x16_bf16 v[64:79], a[236:239], a[156:159], v[64:79]
    buffer_load_dwordx4 v194, s[40:43], s83 offen offset:2048 lds
    s_lshl_b32 s7, s88, 8
    s_add_u32 s7, s7, s10
    s_add_u32 s7, s7, s23
    s_add_u32 s11, s101, 10485760
    v_mfma_f32_32x32x16_bf16 v[48:63], a[236:239], a[152:155], v[48:63]
    s_waitcnt vmcnt(15) lgkmcnt(0)
    s_barrier
    buffer_load_dwordx4 v195, s[44:47], s83 offen offset:3072 lds
    v_mfma_f32_32x32x16_bf16 v[64:79], a[240:243], a[164:167], v[64:79]
    ds_read_b64_tr_b16 a[224:225], v212 offset:32768
    ds_read_b64_tr_b16 a[226:227], v212 offset:33280
    ds_read_b128 a[196:199], v208 offset:53248
    ds_read_b128 a[192:195], v208 offset:49152
    s_lshl_b32 s8, s89, 8
    v_mfma_f32_32x32x16_bf16 v[48:63], a[240:243], a[160:163], v[48:63]
    ds_read_b64_tr_b16 a[228:229], v212 offset:34816
    ds_read_b64_tr_b16 a[230:231], v212 offset:35328
    ds_read_b128 a[204:207], v209 offset:53248
    s_add_u32 s8, s8, s11
    s_add_u32 s8, s8, s23
    s_mul_i32 s4, s99, 14336
    s_add_u32 s4, s4, s80
    v_mfma_f32_32x32x16_bf16 v[64:79], a[244:247], a[172:175], v[64:79]
    ds_read_b128 a[200:203], v209 offset:49152
    ds_read_b64_tr_b16 a[232:233], v212 offset:36864
    ds_read_b64_tr_b16 a[234:235], v212 offset:37376
    ds_read_b128 a[212:215], v210 offset:53248
    s_mul_i32 s5, s80, 448
    s_mov_b64 s[68:69], s[30:31]
    s_nop 0
    s_mov_b32 s70, 3670016
    v_mfma_f32_32x32x16_bf16 v[48:63], a[244:247], a[168:171], v[48:63]
    ds_read_b128 a[208:211], v210 offset:49152
    ds_read_b64_tr_b16 a[236:237], v212 offset:38912
    ds_read_b64_tr_b16 a[238:239], v212 offset:39424
    s_mov_b32 s71, 0x20000
    s_mov_b32 s13, 0
    s_nop 0
    s_mov_b32 s14, 3584
    s_mov_b32 s15, 7168
    v_mfma_f32_32x32x16_bf16 v[64:79], a[248:251], a[180:183], v[64:79]
    ds_read_b128 a[220:223], v211 offset:53248
    ds_read_b128 a[216:219], v211 offset:49152
    s_add_u32 m0, s93, 118784
    v_nop_e64
    buffer_load_dwordx4 v192, s[40:43], s84 offen offset:0 lds
    v_mfma_f32_32x32x16_bf16 v[48:63], a[248:251], a[176:179], v[48:63]
    buffer_load_dwordx4 v193, s[44:47], s84 offen offset:1024 lds
    s_mov_b32 s16, 10752
    s_mov_b32 s17, 14336
    v_mfma_f32_32x32x16_bf16 v[64:79], a[252:255], a[188:191], v[64:79]
    buffer_load_dwordx4 v194, s[40:43], s84 offen offset:2048 lds
    s_mov_b32 s18, 17920
    s_mov_b32 s19, 21504
    s_mov_b32 s20, 25088
    v_mfma_f32_32x32x16_bf16 v[48:63], a[252:255], a[184:187], v[48:63]
    s_waitcnt vmcnt(15) lgkmcnt(0)
    s_barrier
    buffer_load_dwordx4 v195, s[44:47], s84 offen offset:3072 lds
    v_mfma_f32_32x32x16_bf16 v[64:79], a[224:227], a[196:199], v[64:79]
    ds_read_b128 a[240:243], v220 offset:49152
    s_cmp_ge_u32 s90, 2
    s_cselect_b64 s[56:57], s[52:53], s[48:49]
    s_mov_b64 s[58:59], s[50:51]
    s_lshl4_add_u32 s23, s91, s99
    s_lshl_b32 s23, s23, 11
    s_add_u32 s9, s9, s23
    s_add_u32 s10, s10, s23
    v_mfma_f32_32x32x16_bf16 v[48:63], a[224:227], a[192:195], v[48:63]
    ds_read_b128 a[244:247], v221 offset:49152
    s_add_u32 s11, s11, s23
    s_and_b32 s101, s92, 15
    s_lshl_b32 s101, s101, 14
    s_mul_i32 s23, s98, 384
    s_add_u32 s101, s101, s23
    s_add_u32 s101, s101, 114688
    s_mul_i32 s23, s80, 6
    v_mfma_f32_32x32x16_bf16 v[64:79], a[228:231], a[204:207], v[64:79]
    s_add_u32 m0, s93, 36864
    s_nop 0
    buffer_load_dwordx4 v192, s[40:43], s85 offen offset:0 lds
    s_add_u32 s23, s23, s101
    v_min_u32_e64 v254, 16, v1
    v_mfma_f32_32x32x16_bf16 v[48:63], a[228:231], a[200:203], v[48:63]
    ds_read_b128 a[248:251], v222 offset:49152
    v_lshl_add_u32 v254, v254, 2, s23
    s_mul_i32 s23, s99, 64
    s_add_u32 s101, s101, s23
    s_mul_i32 s12, s87, 6
    s_add_u32 s12, s12, s101
    s_add_u32 s101, s101, 128
    v_mfma_f32_32x32x16_bf16 v[64:79], a[232:235], a[212:215], v[64:79]
    ds_read_b128 a[252:255], v223 offset:49152
    s_mul_i32 s26, s88, 6
    s_add_u32 s26, s26, s101
    s_add_u32 s101, s101, 128
    s_mul_i32 s27, s89, 6
    s_add_u32 s27, s27, s101
    v_lshrrev_b32_e64 v229, 6, v1
    v_mfma_f32_32x32x16_bf16 v[48:63], a[232:235], a[208:211], v[48:63]
    buffer_load_dwordx4 v193, s[44:47], s85 offen offset:1024 lds
    v_lshl_add_u32 v229, v229, 24, v1
    v_add_u32 v228, 16384, v1
    s_lshl1_add_u32 s101, s92, s99
    v_mfma_f32_32x32x16_bf16 v[64:79], a[236:239], a[220:223], v[64:79]
    buffer_load_dwordx4 v194, s[40:43], s85 offen offset:2048 lds
    s_mul_i32 s101, s101, 57344
    s_lshl_b32 s23, s98, 7
    s_add_u32 s101, s101, s23
    v_mfma_f32_32x32x16_bf16 v[48:63], a[236:239], a[216:219], v[48:63]
    s_waitcnt vmcnt(15) lgkmcnt(0)
    buffer_load_dwordx4 v195, s[44:47], s85 offen offset:3072 lds
    s_lshl1_add_u32 s101, s80, s101
    v_mul_u32_u24 v5, 7168, v3
    v_mfma_f32_32x32x16_bf16 v[16:31], a[0:3], a[240:243], 0
    ds_read_b128 a[224:227], v224 offset:0
    v_add_u32 v5, v5, v2
    v_lshl_add_u32 v5, v5, 2, s101
    s_mov_b32 s21, 0x3f80
    s_mov_b32 s22, 0x3f800000
    s_mov_b32 s24, 1060205080
    s_mov_b32 s25, 1060205080
    v_mfma_f32_32x32x16_bf16 v[32:47], a[4:7], a[240:243], 0
    ds_read_b128 a[228:231], v225 offset:0
    v_lshlrev_b32 v170, 16, v170
    v_lshlrev_b32 v168, 16, v168
    v_lshlrev_b32 v169, 16, v169
    v_mul_f32 v170, 1069066811, v170
    v_xor_b32 v169, 0x80000000, v169
    v_exp_f32 v170, v170
    v_mul_f32 v117, v168, v168
    v_mfma_f32_32x32x16_bf16 v[16:31], a[8:11], a[244:247], v[16:31]
    s_add_u32 m0, s93, 53248
    s_nop 0
    buffer_load_dwordx4 v192, s[40:43], s86 offen offset:0 lds
    v_cvt_pk_bf16_f32 v170, v170, v170
    v_fmac_f32 v117, v169, v169
    v_lshlrev_b32 v170, 16, v170
    v_rcp_f32 v117, v117
    v_mul_f32 v118, v170, v168
    v_mfma_f32_32x32x16_bf16 v[32:47], a[12:15], a[244:247], v[32:47]
    ds_read_b128 a[232:235], v226 offset:0
    v_mul_f32 v119, v170, v169
    v_mul_f32 v118, 1069066811, v118
    v_mul_f32 v119, 0.15915494, v119
    v_exp_f32 v118, v118
    v_rndne_f32 v115, v119
    v_sub_f32 v119, v119, v115
    v_mfma_f32_32x32x16_bf16 v[16:31], a[16:19], a[248:251], v[16:31]
    ds_read_b128 a[236:239], v227 offset:0
    v_cos_f32 v115, v119
    v_sin_f32 v116, v119
    v_xor_b32 v120, 0x80000000, v253
    v_mul_f32 v122, v115, v118
    v_mul_f32 v123, v116, v118
    v_add_f32 v118, -1.0, v122
    v_add_f32 v117, v117, v117
    v_mfma_f32_32x32x16_bf16 v[32:47], a[20:23], a[248:251], v[32:47]
    buffer_load_dwordx4 v193, s[44:47], s86 offen offset:1024 lds
    v_mul_f32 v241, v118, v168
    v_mul_f32 v242, v123, v168
    v_fmac_f32 v241, v123, v169
    v_fma_f32 v242, -v118, v169, v242
    v_mul_f32 v241, v241, v117
    v_mul_f32 v242, v242, v117
    v_mfma_f32_32x32x16_bf16 v[16:31], a[24:27], a[252:255], v[16:31]
    buffer_load_dwordx4 v194, s[40:43], s86 offen offset:2048 lds
    v_mul_f32 v241, v241, v253
    v_mov_b32 v239, v122
    v_mul_f32 v240, v123, v120
    v_mul_f32 v124, v122, v122
    v_add_f32 v125, v122, v122
    v_fma_f32 v124, -v123, v123, v124
    v_mfma_f32_32x32x16_bf16 v[32:47], a[28:31], a[252:255], v[32:47]
    s_waitcnt vmcnt(15) lgkmcnt(0)
    buffer_load_dwordx4 v195, s[44:47], s86 offen offset:3072 lds
    v_mul_f32 v125, v125, v123
    v_mul_f32 v126, v124, v124
    v_add_f32 v127, v124, v124
    v_fma_f32 v126, -v125, v125, v126
    v_mul_f32 v127, v127, v125
    v_mfma_f32_32x32x16_bf16 v[16:31], a[32:35], a[224:227], v[16:31]
    ds_read_b128 a[240:243], v224 offset:16384
    v_mul_f32 v128, v126, v126
    v_add_f32 v129, v126, v126
    v_fma_f32 v128, -v127, v127, v128
    v_mul_f32 v129, v129, v127
    v_mul_f32 v130, v128, v128
    v_add_f32 v131, v128, v128
    v_fma_f32 v130, -v129, v129, v130
    v_mul_f32 v131, v131, v129
    v_mul_f32 v132, v130, v130
    v_mfma_f32_32x32x16_bf16 v[32:47], a[36:39], a[224:227], v[32:47]
    ds_read_b128 a[244:247], v225 offset:16384
    v_add_f32 v133, v130, v130
    v_fma_f32 v132, -v131, v131, v132
    v_mul_f32 v133, v133, v131
    v_mul_f32 v249, v132, v132
    v_add_f32 v250, v132, v132
    v_fma_f32 v249, -v133, v133, v249
    v_mul_f32 v250, v250, v133
    v_mul_f32 v136, v249, v249
    v_mfma_f32_32x32x16_bf16 v[16:31], a[40:43], a[228:231], v[16:31]
    v_add_u32 v196, 256, v196
    v_add_u32 v197, 256, v197
    v_add_u32 v198, 256, v198
    v_add_u32 v199, 256, v199
    s_add_u32 m0, s93, 69632
    s_mul_i32 s94, s80, 1792
    buffer_load_dwordx4 v196, s[60:63], s94 offen offset:0 lds
    v_mfma_f32_32x32x16_bf16 v[32:47], a[44:47], a[228:231], v[32:47]
    ds_read_b128 a[248:251], v226 offset:16384
    v_add_f32 v137, v249, v249
    v_fma_f32 v136, -v250, v250, v136
    v_mul_f32 v137, v137, v250
    v_mul_f32 v138, v136, v136
    v_add_f32 v139, v136, v136
    v_fma_f32 v138, -v137, v137, v138
    v_mul_f32 v139, v139, v137
    v_mul_f32 v140, v138, v138
    v_add_f32_e64 v141, v138, v138
    v_mfma_f32_32x32x16_bf16 v[16:31], a[48:51], a[232:235], v[16:31]
    ds_read_b128 a[252:255], v227 offset:16384
    v_fma_f32 v140, -v139, v139, v140
    v_mul_f32 v141, v141, v139
    v_mul_f32 v142, v140, v140
    v_add_f32 v143, v140, v140
    v_fma_f32 v142, -v141, v141, v142
    v_mul_f32 v143, v143, v141
    v_cmp_lt_u32 vcc, 0, v3
    v_mov_b32 v243, v130
    v_mfma_f32_32x32x16_bf16 v[32:47], a[52:55], a[232:235], v[32:47]
    buffer_load_dwordx4 v197, s[60:63], s94 offen offset:1024 lds
    v_mul_f32 v244, v131, v120
    v_cndmask_b32 v118, 1.0, v130, vcc
    v_cndmask_b32 v119, 0, v131, vcc
    v_cndmask_b32 v142, 1.0, v142, vcc
    v_cndmask_b32 v143, 0, v143, vcc
    v_cmp_lt_f32 vcc, 0, v120
    v_mfma_f32_32x32x16_bf16 v[16:31], a[56:59], a[236:239], v[16:31]
    buffer_load_dwordx4 v198, s[60:63], s94 offen offset:2048 lds
    v_mul_f32 v245, v122, v118
    v_mul_f32 v246, v122, v119
    v_fma_f32 v245, -v123, v119, v245
    v_fmac_f32 v246, v123, v118
    v_cndmask_b32 v140, 1.0, v140, vcc
    v_cndmask_b32 v141, 0, v141, vcc
    v_mfma_f32_32x32x16_bf16 v[32:47], a[60:63], a[236:239], v[32:47]
    s_waitcnt vmcnt(15) lgkmcnt(0)
    buffer_load_dwordx4 v199, s[60:63], s94 offen offset:3072 lds
    v_mul_f32 v247, v245, v132
    v_mul_f32 v248, v245, v133
    v_fma_f32 v247, -v246, v133, v247
    v_fmac_f32 v248, v246, v132
    v_mul_f32 v118, v140, v142
    v_mfma_f32_32x32x16_bf16 v[16:31], a[64:67], a[240:243], v[16:31]
    ds_read_b128 a[224:227], v224 offset:32768
    v_mul_f32 v119, v140, v143
    v_fma_f32 v118, -v141, v143, v118
    v_fmac_f32 v119, v141, v142
    v_mul_f32 v246, v246, v120
    v_mul_f32 v248, v248, v120
    v_cndmask_b32 v251, v118, v119, vcc
    v_cndmask_b32 v252, -v119, v118, vcc
    v_exp_f32 v8, v64
    v_mfma_f32_32x32x16_bf16 v[32:47], a[68:71], a[240:243], v[32:47]
    ds_read_b128 a[228:231], v225 offset:32768
    v_exp_f32 v9, v65
    v_exp_f32 v10, v66
    v_exp_f32_e64 v11, v67
    v_fma_f32 v12, v8, 0.5, 1.0
    v_fma_f32 v13, v9, 0.5, 1.0
    v_mfma_f32_32x32x16_bf16 v[16:31], a[72:75], a[244:247], v[16:31]
    s_add_u32 m0, s93, 86016
    s_mul_i32 s94, s81, 1792
    buffer_load_dwordx4 v196, s[60:63], s94 offen offset:0 lds
    v_fma_f32 v14, v10, 0.5, 1.0
    v_fma_f32 v15, v11, 0.5, 1.0
    v_fma_f32 v12, v8, v12, 1.0
    v_fma_f32 v13, v9, v13, 1.0
    v_mfma_f32_32x32x16_bf16 v[32:47], a[76:79], a[244:247], v[32:47]
    ds_read_b128 a[232:235], v226 offset:32768
    v_fma_f32 v14, v10, v14, 1.0
    v_fma_f32 v15, v11, v15, 1.0
    v_rcp_f32 v12, v12
    v_rcp_f32 v13, v13
    v_rcp_f32 v14, v14
    v_mfma_f32_32x32x16_bf16 v[16:31], a[80:83], a[248:251], v[16:31]
    ds_read_b128 a[236:239], v227 offset:32768
    v_rcp_f32 v15, v15
    v_fma_f32 v64, -v64, v12, v64
    v_fma_f32 v65, -v65, v13, v65
    v_fma_f32 v66, -v66, v14, v66
    v_fma_f32 v67, -v67, v15, v67
    v_cvt_pk_bf16_f32 v64, v64, v65
    v_cvt_pk_bf16_f32 v65, v66, v67
    v_mfma_f32_32x32x16_bf16 v[32:47], a[84:87], a[248:251], v[32:47]
    buffer_load_dwordx4 v197, s[60:63], s94 offen offset:1024 lds
    v_exp_f32 v8, v68
    v_exp_f32 v9, v69
    v_exp_f32 v10, v70
    v_mfma_f32_32x32x16_bf16 v[16:31], a[88:91], a[252:255], v[16:31]
    buffer_load_dwordx4 v198, s[60:63], s94 offen offset:2048 lds
    v_exp_f32 v11, v71
    v_fma_f32 v12, v8, 0.5, 1.0
    v_fma_f32 v13, v9, 0.5, 1.0
    v_fma_f32 v14, v10, 0.5, 1.0
    v_fma_f32 v15, v11, 0.5, 1.0
    v_fma_f32 v12, v8, v12, 1.0
    v_mfma_f32_32x32x16_bf16 v[32:47], a[92:95], a[252:255], v[32:47]
    s_waitcnt vmcnt(15) lgkmcnt(0)
    buffer_load_dwordx4 v199, s[60:63], s94 offen offset:3072 lds
    v_fma_f32 v13, v9, v13, 1.0
    v_fma_f32 v14, v10, v14, 1.0
    v_fma_f32 v15, v11, v15, 1.0
    v_rcp_f32 v12, v12
    v_mfma_f32_32x32x16_bf16 v[16:31], a[96:99], a[224:227], v[16:31]
    ds_read_b128 a[240:243], v224 offset:49152
    v_rcp_f32 v13, v13
    v_rcp_f32 v14, v14
    v_rcp_f32_e64 v15, v15
    v_fma_f32 v68, -v68, v12, v68
    v_fma_f32 v69, -v69, v13, v69
    v_mfma_f32_32x32x16_bf16 v[32:47], a[100:103], a[224:227], v[32:47]
    ds_read_b128 a[244:247], v225 offset:49152
    v_fma_f32 v70, -v70, v14, v70
    v_fma_f32 v71, -v71, v15, v71
    v_cvt_pk_bf16_f32 v66, v68, v69
    v_cvt_pk_bf16_f32 v67, v70, v71
    v_exp_f32 v8, v48
    v_exp_f32 v9, v49
    v_mfma_f32_32x32x16_bf16 v[16:31], a[104:107], a[228:231], v[16:31]
    s_add_u32 m0, s93, 102400
    s_mul_i32 s94, s82, 1792
    buffer_load_dwordx4 v196, s[60:63], s94 offen offset:0 lds
    v_exp_f32 v10, v50
    v_exp_f32 v11, v51
    v_fma_f32 v12, v8, 0.5, 1.0
    v_mfma_f32_32x32x16_bf16 v[32:47], a[108:111], a[228:231], v[32:47]
    ds_read_b128 a[248:251], v226 offset:49152
    v_fma_f32 v13, v9, 0.5, 1.0
    v_fma_f32 v14, v10, 0.5, 1.0
    v_fma_f32 v15, v11, 0.5, 1.0
    v_fma_f32 v12, v8, v12, 1.0
    v_fma_f32 v13, v9, v13, 1.0
    v_fma_f32 v14, v10, v14, 1.0
    v_fma_f32 v15, v11, v15, 1.0
    v_rcp_f32 v12, v12
    v_mfma_f32_32x32x16_bf16 v[16:31], a[112:115], a[232:235], v[16:31]
    ds_read_b128 a[252:255], v227 offset:49152
    v_rcp_f32 v13, v13
    v_rcp_f32 v14, v14
    v_rcp_f32 v15, v15
    v_fma_f32 v48, -v48, v12, v48
    v_mfma_f32_32x32x16_bf16 v[32:47], a[116:119], a[232:235], v[32:47]
    buffer_load_dwordx4 v197, s[60:63], s94 offen offset:1024 lds
    ds_write_b128 v237, v[64:67] offset:33792
    v_mfma_f32_32x32x16_bf16 v[16:31], a[120:123], a[236:239], v[16:31]
    buffer_load_dwordx4 v198, s[60:63], s94 offen offset:2048 lds
    v_fma_f32 v49, -v49, v13, v49
    v_fma_f32 v50, -v50, v14, v50
    v_fma_f32 v51, -v51, v15, v51
    v_cvt_pk_bf16_f32 v48, v48, v49
    v_cvt_pk_bf16_f32 v49, v50, v51
    v_mfma_f32_32x32x16_bf16 v[32:47], a[124:127], a[236:239], v[32:47]
    s_waitcnt vmcnt(15) lgkmcnt(1)
    buffer_load_dwordx4 v199, s[60:63], s94 offen offset:3072 lds
    v_exp_f32 v8, v52
    v_exp_f32_e64 v9, v53
    v_mfma_f32_32x32x16_bf16 v[16:31], a[128:131], a[240:243], v[16:31]
    ds_read_b128 a[224:227], v220 offset:32768
    s_add_u32 m0, s93, 118784
    s_mul_i32 s94, s83, 1792
    buffer_load_dwordx4 v196, s[60:63], s94 offen offset:0 lds
    v_and_b32 v6, 0xc0, v1
    v_lshl_add_u32 v6, s90, 8, v6
    buffer_load_dword v6, v6, s[36:39], 0 offen sc1
    v_mfma_f32_32x32x16_bf16 v[32:47], a[132:135], a[240:243], v[32:47]
    ds_read_b128 a[228:231], v221 offset:32768
    v_exp_f32 v10, v54
    v_exp_f32 v11, v55
    v_fma_f32 v12, v8, 0.5, 1.0
    v_fma_f32 v13, v9, 0.5, 1.0
    v_fma_f32 v14, v10, 0.5, 1.0
    v_mfma_f32_32x32x16_bf16 v[16:31], a[136:139], a[244:247], v[16:31]
    ds_read_b128 a[232:235], v222 offset:32768
    v_fma_f32 v15, v11, 0.5, 1.0
    v_fma_f32 v12, v8, v12, 1.0
    v_fma_f32 v13, v9, v13, 1.0
    v_fma_f32 v14, v10, v14, 1.0
    v_fma_f32 v15, v11, v15, 1.0
    v_rcp_f32 v12, v12
    v_rcp_f32 v13, v13
    v_mfma_f32_32x32x16_bf16 v[32:47], a[140:143], a[244:247], v[32:47]
    ds_read_b128 a[236:239], v223 offset:32768
    v_rcp_f32 v14, v14
    v_rcp_f32 v15, v15
    v_fma_f32 v52, -v52, v12, v52
    v_fma_f32 v53, -v53, v13, v53
    v_fma_f32 v54, -v54, v14, v54
    v_fma_f32 v55, -v55, v15, v55
    v_mfma_f32_32x32x16_bf16 v[16:31], a[144:147], a[248:251], v[16:31]
    ds_read_b64_tr_b16 v[192:193], v255 offset:0
    ds_read_b64_tr_b16 v[194:195], v255 offset:512
    ds_read_b64_tr_b16 v[208:209], v255 offset:1024
    ds_read_b64_tr_b16 v[210:211], v255 offset:1536
    v_cvt_pk_bf16_f32 v50, v52, v53
    v_cvt_pk_bf16_f32 v51, v54, v55
    v_exp_f32_e64 v8, v72
    v_mfma_f32_32x32x16_bf16 v[32:47], a[148:151], a[248:251], v[32:47]
    buffer_load_dwordx4 v197, s[60:63], s94 offen offset:1024 lds
    ds_write_b128 v237, v[48:51] offset:32768
    v_mfma_f32_32x32x16_bf16 v[16:31], a[152:155], a[252:255], v[16:31]
    buffer_load_dwordx4 v198, s[60:63], s94 offen offset:2048 lds
    v_exp_f32 v9, v73
    v_exp_f32 v10, v74
    v_exp_f32 v11, v75
    v_mfma_f32_32x32x16_bf16 v[32:47], a[156:159], a[252:255], v[32:47]
    s_waitcnt vmcnt(16) lgkmcnt(1)
    buffer_load_dwordx4 v199, s[60:63], s94 offen offset:3072 lds
    v_fma_f32 v12, v8, 0.5, 1.0
    v_fma_f32 v13, v9, 0.5, 1.0
    v_fma_f32 v14, v10, 0.5, 1.0
    v_fma_f32 v15, v11, 0.5, 1.0
    v_mfma_f32_32x32x16_bf16 v[16:31], a[160:163], a[224:227], v[16:31]
    ds_read_b128 a[240:243], v220 offset:49152
    v_fma_f32 v12, v8, v12, 1.0
    v_fma_f32 v13, v9, v13, 1.0
    v_fma_f32 v14, v10, v14, 1.0
    v_fma_f32 v15, v11, v15, 1.0
    v_rcp_f32 v12, v12
    v_rcp_f32 v13, v13
    v_mfma_f32_32x32x16_bf16 v[32:47], a[164:167], a[224:227], v[32:47]
    ds_read_b128 a[244:247], v221 offset:49152
    v_rcp_f32 v14, v14
    v_rcp_f32 v15, v15
    v_fma_f32 v72, -v72, v12, v72
    v_fma_f32 v73, -v73, v13, v73
    v_fma_f32 v74, -v74, v14, v74
    v_fma_f32 v75, -v75, v15, v75
    v_cvt_pk_bf16_f32 v72, v72, v73
    v_mfma_f32_32x32x16_bf16 v[16:31], a[168:171], a[228:231], v[16:31]
    s_add_u32 m0, s93, 36864
    s_mul_i32 s94, s84, 1792
    buffer_load_dwordx4 v196, s[60:63], s94 offen offset:0 lds
    v_cvt_pk_bf16_f32 v73, v74, v75
    v_exp_f32 v8, v76
    v_exp_f32 v9, v77
    v_mfma_f32_32x32x16_bf16 v[32:47], a[172:175], a[228:231], v[32:47]
    ds_read_b128 a[248:251], v222 offset:49152
    v_exp_f32 v10, v78
    v_exp_f32 v11, v79
    v_fma_f32 v12, v8, 0.5, 1.0
    v_fma_f32 v13, v9, 0.5, 1.0
    v_fma_f32 v14, v10, 0.5, 1.0
    v_mfma_f32_32x32x16_bf16 v[16:31], a[176:179], a[232:235], v[16:31]
    ds_read_b128 a[252:255], v223 offset:49152
    v_fma_f32 v15, v11, 0.5, 1.0
    v_fma_f32 v12, v8, v12, 1.0
    v_fma_f32 v13, v9, v13, 1.0
    v_fma_f32 v14, v10, v14, 1.0
    v_fma_f32 v15, v11, v15, 1.0
    v_rcp_f32 v12, v12
    v_rcp_f32 v13, v13
    v_mfma_f32_32x32x16_bf16 v[32:47], a[180:183], a[232:235], v[32:47]
    buffer_load_dwordx4 v197, s[60:63], s94 offen offset:1024 lds
    v_rcp_f32 v14, v14
    v_rcp_f32 v15, v15
    v_fma_f32 v76, -v76, v12, v76
    v_fma_f32 v77, -v77, v13, v77
    v_mfma_f32_32x32x16_bf16 v[16:31], a[184:187], a[236:239], v[16:31]
L_page2:
    s_cbranch_execz L_back0
    s_nop 0
    buffer_load_dwordx4 v198, s[60:63], s94 offen offset:2048 lds
    v_fma_f32 v78, -v78, v14, v78
    v_fma_f32 v79, -v79, v15, v79
    v_cvt_pk_bf16_f32 v74, v76, v77
    v_cvt_pk_bf16_f32 v75, v78, v79
    v_exp_f32 v8, v56
    v_mfma_f32_32x32x16_bf16 v[32:47], a[188:191], a[236:239], v[32:47]
    s_waitcnt vmcnt(12) lgkmcnt(0)
    s_barrier
    buffer_load_dwordx4 v199, s[60:63], s94 offen offset:3072 lds
    v_exp_f32 v9, v57
    v_mfma_f32_32x32x16_bf16 v[16:31], a[192:195], a[240:243], v[16:31]
    ds_read_b64_tr_b16 a[224:225], v213 offset:0
    ds_read_b64_tr_b16 a[226:227], v213 offset:512
    v_exp_f32 v10, v58
    v_exp_f32 v11, v59
    v_fma_f32 v12, v8, 0.5, 1.0
    v_fma_f32 v13, v9, 0.5, 1.0
    v_fma_f32 v14, v10, 0.5, 1.0
    v_fma_f32 v15, v11, 0.5, 1.0
    v_mfma_f32_32x32x16_bf16 v[32:47], a[196:199], a[240:243], v[32:47]
    ds_read_b64_tr_b16 a[228:229], v213 offset:2048
    ds_read_b64_tr_b16 a[230:231], v213 offset:2560
    v_fma_f32 v12, v8, v12, 1.0
    v_fma_f32 v13, v9, v13, 1.0
    v_fma_f32 v14, v10, v14, 1.0
    v_fma_f32 v15, v11, v15, 1.0
    v_rcp_f32 v12, v12
    v_rcp_f32 v13, v13
    v_mfma_f32_32x32x16_bf16 v[16:31], a[200:203], a[244:247], v[16:31]
    s_add_u32 m0, s93, 20480
    s_mul_i32 s94, s85, 1792
    buffer_load_dwordx4 v196, s[60:63], s94 offen offset:0 lds
    v_rcp_f32 v14, v14
    v_rcp_f32 v15, v15
    v_mfma_f32_32x32x16_bf16 v[32:47], a[204:207], a[244:247], v[32:47]
    ds_read_b64_tr_b16 a[232:233], v213 offset:4096
    ds_read_b64_tr_b16 a[234:235], v213 offset:4608
    v_fma_f32 v56, -v56, v12, v56
    v_fma_f32 v57, -v57, v13, v57
    v_fma_f32 v58, -v58, v14, v58
    v_fma_f32 v59, -v59, v15, v59
    v_cvt_pk_bf16_f32 v56, v56, v57
    v_cvt_pk_bf16_f32 v57, v58, v59
    v_mfma_f32_32x32x16_bf16 v[16:31], a[208:211], a[248:251], v[16:31]
    ds_read_b64_tr_b16 a[236:237], v213 offset:6144
    ds_read_b64_tr_b16 a[238:239], v213 offset:6656
    v_exp_f32 v8, v60
    v_exp_f32 v9, v61
    v_exp_f32 v10, v62
    v_exp_f32 v11, v63
    v_mfma_f32_32x32x16_bf16 v[32:47], a[212:215], a[248:251], v[32:47]
    buffer_load_dwordx4 v197, s[60:63], s94 offen offset:1024 lds
    ds_write_b128 v237, v[72:75] offset:41984
    v_mfma_f32_32x32x16_bf16 v[16:31], a[216:219], a[252:255], v[16:31]
    buffer_load_dwordx4 v198, s[60:63], s94 offen offset:2048 lds
    v_fma_f32 v12, v8, 0.5, 1.0
    v_fma_f32 v13, v9, 0.5, 1.0
    v_fma_f32 v14, v10, 0.5, 1.0
    v_fma_f32 v15, v11, 0.5, 1.0
    v_mfma_f32_32x32x16_bf16 v[32:47], a[220:223], a[252:255], v[32:47]
    s_waitcnt lgkmcnt(1)
    buffer_load_dwordx4 v199, s[60:63], s94 offen offset:3072 lds
    v_fma_f32 v12, v8, v12, 1.0
    v_fma_f32 v13, v9, v13, 1.0
    v_fma_f32 v14, v10, v14, 1.0
    v_fma_f32 v15, v11, v15, 1.0
    v_rcp_f32 v12, v12
    v_mfma_f32_32x32x16_bf16 v[96:111], a[224:227], a[4:7], v[80:95]
    ds_read_b64_tr_b16 a[240:241], v213 offset:16384
    ds_read_b64_tr_b16 a[242:243], v213 offset:16896
    v_rcp_f32 v13, v13
    v_rcp_f32 v14, v14
    v_rcp_f32_e64 v15, v15
    v_fma_f32 v60, -v60, v12, v60
    v_mfma_f32_32x32x16_bf16 v[80:95], a[224:227], a[0:3], v[80:95]
    ds_read_b64_tr_b16 a[244:245], v213 offset:18432
    ds_read_b64_tr_b16 a[246:247], v213 offset:18944
    v_fma_f32 v61, -v61, v13, v61
    v_fma_f32 v62, -v62, v14, v62
    v_fma_f32 v63, -v63, v15, v63
    v_cvt_pk_bf16_f32 v58, v60, v61
    v_cvt_pk_bf16_f32 v59, v62, v63
    v_mfma_f32_32x32x16_bf16 v[96:111], a[228:231], a[12:15], v[96:111]
    s_add_u32 m0, s93, 53248
    s_mul_i32 s94, s86, 1792
    buffer_load_dwordx4 v196, s[60:63], s94 offen offset:0 lds
    v_mul_f32_dpp v12, v16, v242 row_ror:8 row_mask:0xf bank_mask:0xf bound_ctrl:0
    v_mul_f32_dpp v13, v32, v242 row_ror:8 row_mask:0xf bank_mask:0xf bound_ctrl:0
    v_fma_f32 v16, v241, v16, v12
    v_fma_f32 v32, v241, v32, v13
    v_mul_f32_dpp v12, v17, v242 row_ror:8 row_mask:0xf bank_mask:0xf bound_ctrl:0
    v_mul_f32_dpp v13, v33, v242 row_ror:8 row_mask:0xf bank_mask:0xf bound_ctrl:0
    v_mfma_f32_32x32x16_bf16 v[80:95], a[228:231], a[8:11], v[80:95]
    ds_read_b64_tr_b16 a[248:249], v213 offset:20480
    ds_read_b64_tr_b16 a[250:251], v213 offset:20992
    v_fma_f32 v17, v241, v17, v12
    v_fma_f32 v33, v241, v33, v13
    v_fma_f32 v10, v239, v16, v17
    v_fma_f32 v11, v239, v32, v33
    v_mul_f32_dpp v12, v18, v242 row_ror:8 row_mask:0xf bank_mask:0xf bound_ctrl:0
    v_mul_f32_dpp v13, v34, v242 row_ror:8 row_mask:0xf bank_mask:0xf bound_ctrl:0
    v_fmac_f32_dpp v10, v16, v240 row_ror:8 row_mask:0xf bank_mask:0xf
    v_fmac_f32_dpp v11, v32, v240 row_ror:8 row_mask:0xf bank_mask:0xf
    v_mfma_f32_32x32x16_bf16 v[96:111], a[232:235], a[20:23], v[96:111]
    ds_read_b64_tr_b16 a[252:253], v213 offset:22528
    ds_read_b64_tr_b16 a[254:255], v213 offset:23040
    v_fma_f32 v18, v241, v18, v12
    v_fma_f32 v34, v241, v34, v13
    v_fma_f32 v8, v239, v10, v18
    v_fma_f32 v9, v239, v11, v34
    v_mul_f32_dpp v12, v19, v242 row_ror:8 row_mask:0xf bank_mask:0xf bound_ctrl:0
    v_mul_f32_dpp v13, v35, v242 row_ror:8 row_mask:0xf bank_mask:0xf bound_ctrl:0
    v_fmac_f32_dpp v8, v10, v240 row_ror:8 row_mask:0xf bank_mask:0xf
    v_fmac_f32_dpp v9, v11, v240 row_ror:8 row_mask:0xf bank_mask:0xf
    v_mfma_f32_32x32x16_bf16 v[80:95], a[232:235], a[16:19], v[80:95]
    buffer_load_dwordx4 v197, s[60:63], s94 offen offset:1024 lds
    ds_write_b128 v237, v[56:59] offset:40960
    v_mfma_f32_32x32x16_bf16 v[96:111], a[236:239], a[28:31], v[96:111]
    buffer_load_dwordx4 v198, s[60:63], s94 offen offset:2048 lds
    v_fma_f32 v19, v241, v19, v12
    v_fma_f32 v35, v241, v35, v13
    v_fma_f32 v10, v239, v8, v19
    v_fma_f32 v11, v239, v9, v35
    v_mul_f32_dpp v12, v20, v242 row_ror:8 row_mask:0xf bank_mask:0xf bound_ctrl:0
    v_mul_f32_dpp v13, v36, v242 row_ror:8 row_mask:0xf bank_mask:0xf bound_ctrl:0
    v_fmac_f32_dpp v10, v8, v240 row_ror:8 row_mask:0xf bank_mask:0xf
    v_mfma_f32_32x32x16_bf16 v[80:95], a[236:239], a[24:27], v[80:95]
    s_waitcnt vmcnt(11) lgkmcnt(1)
    s_barrier
    buffer_load_dwordx4 v199, s[60:63], s94 offen offset:3072 lds
    v_fmac_f32_dpp v11, v9, v240 row_ror:8 row_mask:0xf bank_mask:0xf
    v_fma_f32 v20, v241, v20, v12
    v_fma_f32 v36, v241, v36, v13
    v_fma_f32 v8, v239, v10, v20
    v_mfma_f32_32x32x16_bf16 v[96:111], a[240:243], a[36:39], v[96:111]
    ds_read_b64_tr_b16 a[224:225], v213 offset:32768
    ds_read_b64_tr_b16 a[226:227], v213 offset:33280
    v_fma_f32 v9, v239, v11, v36
    v_mul_f32_dpp v12, v21, v242 row_ror:8 row_mask:0xf bank_mask:0xf bound_ctrl:0
    v_mul_f32_dpp v13, v37, v242 row_ror:8 row_mask:0xf bank_mask:0xf bound_ctrl:0
    v_fmac_f32_dpp v8, v10, v240 row_ror:8 row_mask:0xf bank_mask:0xf
    v_fmac_f32_dpp v9, v11, v240 row_ror:8 row_mask:0xf bank_mask:0xf
    v_fma_f32 v21, v241, v21, v12
    v_fma_f32 v37, v241, v37, v13
    v_fma_f32 v10, v239, v8, v21
    v_mfma_f32_32x32x16_bf16 v[80:95], a[240:243], a[32:35], v[80:95]
    ds_read_b64_tr_b16 a[228:229], v213 offset:34816
    ds_read_b64_tr_b16 a[230:231], v213 offset:35328
    v_fma_f32 v11, v239, v9, v37
    v_mul_f32_dpp v12, v22, v242 row_ror:8 row_mask:0xf bank_mask:0xf bound_ctrl:0
    v_mul_f32_dpp v13, v38, v242 row_ror:8 row_mask:0xf bank_mask:0xf bound_ctrl:0
    v_fmac_f32_dpp v10, v8, v240 row_ror:8 row_mask:0xf bank_mask:0xf
    v_fmac_f32_dpp v11, v9, v240 row_ror:8 row_mask:0xf bank_mask:0xf
    v_fma_f32 v22, v241, v22, v12
    v_fma_f32 v38, v241, v38, v13
    v_fma_f32 v8, v239, v10, v22
    v_mfma_f32_32x32x16_bf16 v[96:111], a[244:247], a[44:47], v[96:111]
    s_add_u32 m0, s93, 69632
    s_add_u32 s94, s87, 0
    s_nop 0
    buffer_load_dwordx4 v200, s[64:67], s94 offen offset:0 lds
    v_fma_f32 v9, v239, v11, v38
    v_mul_f32_dpp v12, v23, v242 row_ror:8 row_mask:0xf bank_mask:0xf bound_ctrl:0
    v_mul_f32_dpp v13, v39, v242 row_ror:8 row_mask:0xf bank_mask:0xf bound_ctrl:0
    v_fmac_f32_dpp v8, v10, v240 row_ror:8 row_mask:0xf bank_mask:0xf
    v_fmac_f32_dpp v9, v11, v240 row_ror:8 row_mask:0xf bank_mask:0xf
    v_fma_f32 v23, v241, v23, v12
    v_mfma_f32_32x32x16_bf16 v[80:95], a[244:247], a[40:43], v[80:95]
    ds_read_b64_tr_b16 a[232:233], v213 offset:36864
    ds_read_b64_tr_b16 a[234:235], v213 offset:37376
    v_fma_f32 v39, v241, v39, v13
    v_fma_f32 v10, v239, v8, v23
    v_fma_f32 v11, v239, v9, v39
    v_mul_f32_dpp v12, v24, v242 row_ror:8 row_mask:0xf bank_mask:0xf bound_ctrl:0
    v_mul_f32_dpp v13, v40, v242 row_ror:8 row_mask:0xf bank_mask:0xf bound_ctrl:0
    v_fmac_f32_dpp v10, v8, v240 row_ror:8 row_mask:0xf bank_mask:0xf
    v_fmac_f32_dpp v11, v9, v240 row_ror:8 row_mask:0xf bank_mask:0xf
    v_fma_f32 v24, v241, v24, v12
    v_mfma_f32_32x32x16_bf16 v[96:111], a[248:251], a[52:55], v[96:111]
    ds_read_b64_tr_b16 a[236:237], v213 offset:38912
    ds_read_b64_tr_b16 a[238:239], v213 offset:39424
    v_fma_f32 v40, v241, v40, v13
    v_fma_f32 v8, v239, v10, v24
    v_fma_f32 v9, v239, v11, v40
    v_mul_f32_dpp v12, v25, v242 row_ror:8 row_mask:0xf bank_mask:0xf bound_ctrl:0
    v_mul_f32_dpp v13, v41, v242 row_ror:8 row_mask:0xf bank_mask:0xf bound_ctrl:0
    v_fmac_f32_dpp v8, v10, v240 row_ror:8 row_mask:0xf bank_mask:0xf
    v_fmac_f32_dpp v9, v11, v240 row_ror:8 row_mask:0xf bank_mask:0xf
    v_fma_f32 v25, v241, v25, v12
    v_fma_f32 v41, v241, v41, v13
    v_mfma_f32_32x32x16_bf16 v[80:95], a[248:251], a[48:51], v[80:95]
    buffer_load_dwordx4 v201, s[64:67], s94 offen offset:1024 lds
    v_fma_f32 v10, v239, v8, v25
    v_fma_f32 v11, v239, v9, v41
    v_mul_f32_dpp v12, v26, v242 row_ror:8 row_mask:0xf bank_mask:0xf bound_ctrl:0
    v_mul_f32_dpp v13, v42, v242 row_ror:8 row_mask:0xf bank_mask:0xf bound_ctrl:0
    v_fmac_f32_dpp v10, v8, v240 row_ror:8 row_mask:0xf bank_mask:0xf
    v_fmac_f32_dpp v11, v9, v240 row_ror:8 row_mask:0xf bank_mask:0xf
    v_fma_f32 v26, v241, v26, v12
    v_mfma_f32_32x32x16_bf16 v[96:111], a[252:255], a[60:63], v[96:111]
    buffer_load_dwordx4 v202, s[64:67], s94 offen offset:2048 lds
    v_fma_f32 v42, v241, v42, v13
    v_fma_f32 v8, v239, v10, v26
    v_fma_f32 v9, v239, v11, v42
    v_mul_f32_dpp v12, v27, v242 row_ror:8 row_mask:0xf bank_mask:0xf bound_ctrl:0
    v_mul_f32_dpp v13, v43, v242 row_ror:8 row_mask:0xf bank_mask:0xf bound_ctrl:0
    v_fmac_f32_dpp v8, v10, v240 row_ror:8 row_mask:0xf bank_mask:0xf
    v_fmac_f32_dpp v9, v11, v240 row_ror:8 row_mask:0xf bank_mask:0xf
    v_mfma_f32_32x32x16_bf16 v[80:95], a[252:255], a[56:59], v[80:95]
    s_waitcnt lgkmcnt(0)
    s_nop 0
    buffer_load_dwordx4 v203, s[64:67], s94 offen offset:3072 lds
    v_fma_f32 v27, v241, v27, v12
    v_fma_f32 v43, v241, v43, v13
    v_fma_f32 v10, v239, v8, v27
    v_fma_f32 v11, v239, v9, v43
    v_mul_f32_dpp v12, v28, v242 row_ror:8 row_mask:0xf bank_mask:0xf bound_ctrl:0
    v_mul_f32_dpp v13, v44, v242 row_ror:8 row_mask:0xf bank_mask:0xf bound_ctrl:0
    v_mfma_f32_32x32x16_bf16 v[96:111], a[224:227], a[68:71], v[96:111]
    ds_read_b64_tr_b16 a[240:241], v213 offset:49152
    ds_read_b64_tr_b16 a[242:243], v213 offset:49664
    v_cmp_eq_u32 s[96:97], s90, v6
    v_nop_e64
    s_cmp_lg_u64 s[96:97], 0
    s_cbranch_scc1 L_ready_e
L_ready_e_ok:
    v_fmac_f32_dpp v10, v8, v240 row_ror:8 row_mask:0xf bank_mask:0xf
    v_fmac_f32_dpp v11, v9, v240 row_ror:8 row_mask:0xf bank_mask:0xf
    v_fma_f32 v28, v241, v28, v12
    v_fma_f32 v44, v241, v44, v13
    v_fma_f32 v8, v239, v10, v28
    v_fma_f32 v9, v239, v11, v44
    v_mfma_f32_32x32x16_bf16 v[80:95], a[224:227], a[64:67], v[80:95]
    ds_read_b64_tr_b16 a[244:245], v213 offset:51200
    ds_read_b64_tr_b16 a[246:247], v213 offset:51712
    v_mul_f32_dpp v12, v29, v242 row_ror:8 row_mask:0xf bank_mask:0xf bound_ctrl:0
    v_mul_f32_dpp v13, v45, v242 row_ror:8 row_mask:0xf bank_mask:0xf bound_ctrl:0
    v_fmac_f32_dpp v8, v10, v240 row_ror:8 row_mask:0xf bank_mask:0xf
    v_fmac_f32_dpp v9, v11, v240 row_ror:8 row_mask:0xf bank_mask:0xf
    v_fma_f32 v29, v241, v29, v12
    v_fma_f32 v45, v241, v45, v13
    v_fma_f32 v10, v239, v8, v29
    v_fma_f32 v11, v239, v9, v45
    v_mfma_f32_32x32x16_bf16 v[96:111], a[228:231], a[76:79], v[96:111]
    s_add_u32 m0, s93, 86016
    s_add_u32 s94, s88, 0
    s_nop 0
    buffer_load_dwordx4 v200, s[64:67], s94 offen offset:0 lds
    v_mul_f32_dpp v12, v30, v242 row_ror:8 row_mask:0xf bank_mask:0xf bound_ctrl:0
    v_mul_f32_dpp v13, v46, v242 row_ror:8 row_mask:0xf bank_mask:0xf bound_ctrl:0
    v_fmac_f32_dpp v10, v8, v240 row_ror:8 row_mask:0xf bank_mask:0xf
    v_fmac_f32_dpp v11, v9, v240 row_ror:8 row_mask:0xf bank_mask:0xf
    v_fma_f32 v30, v241, v30, v12
    v_fma_f32 v46, v241, v46, v13
    v_mfma_f32_32x32x16_bf16 v[80:95], a[228:231], a[72:75], v[80:95]
    ds_read_b64_tr_b16 a[248:249], v213 offset:53248
    ds_read_b64_tr_b16 a[250:251], v213 offset:53760
    v_fma_f32 v8, v239, v10, v30
    v_fma_f32 v9, v239, v11, v46
    v_mul_f32_dpp v12, v31, v242 row_ror:8 row_mask:0xf bank_mask:0xf bound_ctrl:0
    v_mul_f32_dpp v13, v47, v242 row_ror:8 row_mask:0xf bank_mask:0xf bound_ctrl:0
    v_fmac_f32_dpp v8, v10, v240 row_ror:8 row_mask:0xf bank_mask:0xf
    v_fmac_f32_dpp v9, v11, v240 row_ror:8 row_mask:0xf bank_mask:0xf
    v_fma_f32 v31, v241, v31, v12
    v_fma_f32 v47, v241, v47, v13
    v_mfma_f32_32x32x16_bf16 v[96:111], a[232:235], a[84:87], v[96:111]
    ds_read_b64_tr_b16 a[252:253], v213 offset:55296
    ds_read_b64_tr_b16 a[254:255], v213 offset:55808
    v_fma_f32 v10, v239, v8, v31
    v_fma_f32 v11, v239, v9, v47
    v_cmp_lt_u32 vcc, 0, v3
    v_fmac_f32_dpp v10, v8, v240 row_ror:8 row_mask:0xf bank_mask:0xf
    v_fmac_f32_dpp v11, v9, v240 row_ror:8 row_mask:0xf bank_mask:0xf
    v_mov_b32 v8, v10
    v_mov_b32 v112, v11
    s_nop 0
    v_permlane32_swap_b32 v10, v8
    v_permlane32_swap_b32 v11, v112
    v_mfma_f32_32x32x16_bf16 v[80:95], a[232:235], a[80:83], v[80:95]
    buffer_load_dwordx4 v201, s[64:67], s94 offen offset:1024 lds
    v_cndmask_b32 v12, 0, v10, vcc
    v_fmac_f32_dpp v8, v10, v244 row_ror:8 row_mask:0xf bank_mask:0xf
    v_fmac_f32 v8, v243, v10
    v_fmac_f32_dpp v16, v12, v240 row_ror:8 row_mask:0xf bank_mask:0xf
    v_fmac_f32 v16, v239, v12
    v_fmac_f32_dpp v11, v8, v244 row_ror:8 row_mask:0xf bank_mask:0xf
    v_fmac_f32 v11, v243, v8
    v_mfma_f32_32x32x16_bf16 v[96:111], a[236:239], a[92:95], v[96:111]
    buffer_load_dwordx4 v202, s[64:67], s94 offen offset:2048 lds
    v_cndmask_b32 v8, v8, v11, vcc
    v_fmac_f32_dpp v112, v11, v244 row_ror:8 row_mask:0xf bank_mask:0xf
    v_fmac_f32 v112, v243, v11
    v_min_u32 v112, -2, v112
    v_fmac_f32_dpp v32, v8, v240 row_ror:8 row_mask:0xf bank_mask:0xf
    v_fmac_f32 v32, v239, v8
    v_mov_b32_dpp v113, v112 row_ror:8 row_mask:0xf bank_mask:0xf bound_ctrl:0
    v_mfma_f32_32x32x16_bf16 v[80:95], a[236:239], a[88:91], v[80:95]
    s_waitcnt vmcnt(15) lgkmcnt(0)
    s_barrier
    buffer_load_dwordx4 v203, s[64:67], s94 offen offset:3072 lds
    buffer_store_dwordx2 v[112:113], v214, s[72:75], 0 offen sc1
    v_mfma_f32_32x32x16_bf16 v[96:111], a[240:243], a[100:103], v[96:111]
    ds_read_b64_tr_b16 a[224:225], v212 offset:32768
    ds_read_b64_tr_b16 a[226:227], v212 offset:33280
    v_mfma_f32_32x32x16_bf16 v[80:95], a[240:243], a[96:99], v[80:95]
    ds_read_b64_tr_b16 a[228:229], v212 offset:34816
    ds_read_b64_tr_b16 a[230:231], v212 offset:35328
    v_mfma_f32_32x32x16_bf16 v[96:111], a[244:247], a[108:111], v[96:111]
    s_add_u32 m0, s93, 102400
    s_add_u32 s94, s89, 0
    s_nop 0
    buffer_load_dwordx4 v200, s[64:67], s94 offen offset:0 lds
    v_mfma_f32_32x32x16_bf16 v[80:95], a[244:247], a[104:107], v[80:95]
    ds_read_b64_tr_b16 a[232:233], v212 offset:36864
    ds_read_b64_tr_b16 a[234:235], v212 offset:37376
    v_mfma_f32_32x32x16_bf16 v[96:111], a[248:251], a[116:119], v[96:111]
    ds_read_b64_tr_b16 a[236:237], v212 offset:38912
    ds_read_b64_tr_b16 a[238:239], v212 offset:39424
    v_mfma_f32_32x32x16_bf16 v[80:95], a[248:251], a[112:115], v[80:95]
    buffer_load_dwordx4 v201, s[64:67], s94 offen offset:1024 lds
    v_mfma_f32_32x32x16_bf16 v[96:111], a[252:255], a[124:127], v[96:111]
    buffer_load_dwordx4 v202, s[64:67], s94 offen offset:2048 lds
    v_mfma_f32_32x32x16_bf16 v[80:95], a[252:255], a[120:123], v[80:95]
    s_waitcnt vmcnt(16) lgkmcnt(0)
    s_barrier
    buffer_load_dwordx4 v203, s[64:67], s94 offen offset:3072 lds
    v_mfma_f32_32x32x16_bf16 v[96:111], a[224:227], a[132:135], v[96:111]
    ds_read_b64_tr_b16 a[240:241], v212 offset:16384
    ds_read_b64_tr_b16 a[242:243], v212 offset:16896
    ds_read_b64_tr_b16 a[244:245], v212 offset:18432
    ds_read_b64_tr_b16 a[246:247], v212 offset:18944
    ds_read_b64_tr_b16 a[248:249], v212 offset:20480
    ds_read_b64_tr_b16 a[250:251], v212 offset:20992
    v_mfma_f32_32x32x16_bf16 v[80:95], a[224:227], a[128:131], v[80:95]
    ds_read_b64_tr_b16 a[252:253], v212 offset:22528
    ds_read_b64_tr_b16 a[254:255], v212 offset:23040
    ds_read_b128 a[0:3], v1 offset:32768
    v_mfma_f32_32x32x16_bf16 v[96:111], a[228:231], a[140:143], v[96:111]
    ds_read_b128 a[4:7], v1 offset:33792
    ds_read_b128 a[8:11], v1 offset:34816
    ds_read_b128 a[12:15], v1 offset:35840
    v_mfma_f32_32x32x16_bf16 v[80:95], a[228:231], a[136:139], v[80:95]
    ds_read_b128 a[16:19], v1 offset:36864
    ds_read_b128 a[20:23], v1 offset:37888
    s_add_u32 m0, s93, 118784
    s_add_u32 s94, s87, 14336
    buffer_load_dwordx4 v200, s[64:67], s94 offen offset:0 lds
    v_mfma_f32_32x32x16_bf16 v[96:111], a[232:235], a[148:151], v[96:111]
    ds_read_b128 a[24:27], v1 offset:38912
    ds_read_b128 a[28:31], v1 offset:39936
    v_mfma_f32_32x32x16_bf16 v[80:95], a[232:235], a[144:147], v[80:95]
    buffer_load_dwordx4 v201, s[64:67], s94 offen offset:1024 lds
    v_mfma_f32_32x32x16_bf16 v[96:111], a[236:239], a[156:159], v[96:111]
    buffer_load_dwordx4 v202, s[64:67], s94 offen offset:2048 lds
    v_mfma_f32_32x32x16_bf16 v[80:95], a[236:239], a[152:155], v[80:95]
    s_waitcnt vmcnt(12) lgkmcnt(0)
    s_barrier
    buffer_load_dwordx4 v203, s[64:67], s94 offen offset:3072 lds
    v_mfma_f32_32x32x16_bf16 v[96:111], a[240:243], a[164:167], v[96:111]
    ds_read_b64_tr_b16 a[224:225], v212 offset:49152
    ds_read_b64_tr_b16 a[226:227], v212 offset:49664
    ds_read_b64_tr_b16 a[228:229], v212 offset:51200
    ds_read_b64_tr_b16 a[230:231], v212 offset:51712
    ds_read_b64_tr_b16 a[232:233], v212 offset:53248
    ds_read_b64_tr_b16 a[234:235], v212 offset:53760
    v_mfma_f32_32x32x16_bf16 v[80:95], a[240:243], a[160:163], v[80:95]
    ds_read_b64_tr_b16 a[236:237], v212 offset:55296
    ds_read_b64_tr_b16 a[238:239], v212 offset:55808
    ds_read_b128 a[32:35], v1 offset:40960
    v_mfma_f32_32x32x16_bf16 v[96:111], a[244:247], a[172:175], v[96:111]
    ds_read_b128 a[36:39], v1 offset:41984
    ds_read_b128 a[40:43], v1 offset:43008
    ds_read_b128 a[44:47], v1 offset:44032
    v_mfma_f32_32x32x16_bf16 v[80:95], a[244:247], a[168:171], v[80:95]
    ds_read_b128 a[48:51], v1 offset:45056
    ds_read_b128 a[52:55], v1 offset:46080
    s_add_u32 m0, s93, 36864
    s_add_u32 s94, s88, 14336
    buffer_load_dwordx4 v200, s[64:67], s94 offen offset:0 lds
    v_mfma_f32_32x32x16_bf16 v[96:111], a[248:251], a[180:183], v[96:111]
    ds_read_b128 a[56:59], v1 offset:47104
    ds_read_b128 a[60:63], v1 offset:48128
    v_mfma_f32_32x32x16_bf16 v[80:95], a[248:251], a[176:179], v[80:95]
    buffer_load_dwordx4 v201, s[64:67], s94 offen offset:1024 lds
    v_mfma_f32_32x32x16_bf16 v[96:111], a[252:255], a[188:191], v[96:111]
    buffer_load_dwordx4 v202, s[64:67], s94 offen offset:2048 lds
    v_mfma_f32_32x32x16_bf16 v[80:95], a[252:255], a[184:187], v[80:95]
    s_waitcnt lgkmcnt(0)
    s_nop 0
    buffer_load_dwordx4 v203, s[64:67], s94 offen offset:3072 lds
    v_mfma_f32_32x32x16_bf16 v[96:111], a[224:227], a[196:199], v[96:111]
    ds_read_b64_tr_b16 a[240:241], v231 offset:0
    ds_read_b64_tr_b16 a[242:243], v231 offset:1024
    v_mfma_f32_32x32x16_bf16 v[80:95], a[224:227], a[192:195], v[80:95]
    ds_read_b64_tr_b16 a[244:245], v231 offset:2048
    ds_read_b64_tr_b16 a[246:247], v231 offset:3072
    v_mfma_f32_32x32x16_bf16 v[96:111], a[228:231], a[204:207], v[96:111]
    s_add_u32 m0, s93, 20480
    s_add_u32 s94, s89, 14336
    buffer_load_dwordx4 v200, s[64:67], s94 offen offset:0 lds
    v_mfma_f32_32x32x16_bf16 v[80:95], a[228:231], a[200:203], v[80:95]
    ds_read_b64_tr_b16 a[248:249], v231 offset:4096
    ds_read_b64_tr_b16 a[250:251], v231 offset:5120
    v_mfma_f32_32x32x16_bf16 v[96:111], a[232:235], a[212:215], v[96:111]
    ds_read_b64_tr_b16 a[252:253], v231 offset:6144
    ds_read_b64_tr_b16 a[254:255], v231 offset:7168
    v_mfma_f32_32x32x16_bf16 v[80:95], a[232:235], a[208:211], v[80:95]
    buffer_load_dwordx4 v201, s[64:67], s94 offen offset:1024 lds
    v_mfma_f32_32x32x16_bf16 v[96:111], a[236:239], a[220:223], v[96:111]
    buffer_load_dwordx4 v202, s[64:67], s94 offen offset:2048 lds
    buffer_load_dwordx2 v[190:191], v4, s[72:75], 0 offen offset:896 sc1
    v_mfma_f32_32x32x16_bf16 v[80:95], a[236:239], a[216:219], v[80:95]
    s_waitcnt vmcnt(12) lgkmcnt(0)
    s_barrier
    buffer_load_dwordx4 v203, s[64:67], s94 offen offset:3072 lds
    v_mfma_f32_32x32x16_bf16 v[112:127], a[0:3], a[240:243], 0
    ds_read_b64_tr_b16 a[224:225], v231 offset:16384
    ds_read_b64_tr_b16 a[226:227], v231 offset:17408
    buffer_load_dwordx2 v[188:189], v4, s[72:75], 0 offen offset:768 sc1
    v_mfma_f32_32x32x16_bf16 v[128:143], a[4:7], a[240:243], 0
    ds_read_b64_tr_b16 a[228:229], v231 offset:18432
    ds_read_b64_tr_b16 a[230:231], v231 offset:19456
    v_exp_f32 v8, v96
    v_exp_f32 v9, v97
    v_exp_f32 v10, v98
    v_exp_f32 v11, v99
    v_fma_f32 v12, v8, 0.5, 1.0
    v_fma_f32 v13, v9, 0.5, 1.0
    v_fma_f32 v14, v10, 0.5, 1.0
    v_fma_f32 v15, v11, 0.5, 1.0
    v_mfma_f32_32x32x16_bf16 v[112:127], a[8:11], a[244:247], v[112:127]
    s_add_u32 m0, s93, 53248
    s_add_u32 s94, s87, 114688
    buffer_load_dwordx4 v200, s[64:67], s94 offen offset:0 lds
    v_fma_f32 v12, v8, v12, 1.0
    v_fma_f32 v13, v9, v13, 1.0
    v_fma_f32 v14, v10, v14, 1.0
    v_fma_f32 v15, v11, v15, 1.0
    v_rcp_f32 v12, v12
    v_rcp_f32 v13, v13
    v_mfma_f32_32x32x16_bf16 v[128:143], a[12:15], a[244:247], v[128:143]
    ds_read_b64_tr_b16 a[232:233], v231 offset:20480
    ds_read_b64_tr_b16 a[234:235], v231 offset:21504
    buffer_load_dwordx2 v[186:187], v4, s[72:75], 0 offen offset:640 sc1
    v_rcp_f32 v14, v14
    v_rcp_f32 v15, v15
    v_fma_f32 v96, -v96, v12, v96
    v_fma_f32 v97, -v97, v13, v97
    v_fma_f32 v98, -v98, v14, v98
    v_fma_f32 v99, -v99, v15, v99
    v_cvt_pk_bf16_f32 v96, v96, v97
    v_mfma_f32_32x32x16_bf16 v[112:127], a[16:19], a[248:251], v[112:127]
    ds_read_b64_tr_b16 a[236:237], v231 offset:22528
    ds_read_b64_tr_b16 a[238:239], v231 offset:23552
    buffer_load_dwordx2 v[184:185], v4, s[72:75], 0 offen offset:512 sc1
    v_cvt_pk_bf16_f32 v97, v98, v99
    v_exp_f32 v8, v100
    v_exp_f32 v9, v101
    v_exp_f32 v10, v102
    v_exp_f32 v11, v103
    v_mfma_f32_32x32x16_bf16 v[128:143], a[20:23], a[248:251], v[128:143]
    buffer_load_dwordx4 v201, s[64:67], s94 offen offset:1024 lds
    v_fma_f32 v12, v8, 0.5, 1.0
    v_fma_f32 v13, v9, 0.5, 1.0
    v_fma_f32 v14, v10, 0.5, 1.0
    v_fma_f32 v15, v11, 0.5, 1.0
    v_fma_f32 v12, v8, v12, 1.0
    v_fma_f32 v13, v9, v13, 1.0
    v_fma_f32 v14, v10, v14, 1.0
    v_fma_f32 v15, v11, v15, 1.0
    v_rcp_f32_e64 v12, v12
    v_mfma_f32_32x32x16_bf16 v[112:127], a[24:27], a[252:255], v[112:127]
    buffer_load_dwordx4 v202, s[64:67], s94 offen offset:2048 lds
    buffer_load_dwordx2 v[182:183], v4, s[72:75], 0 offen offset:384 sc1
    v_rcp_f32 v13, v13
    v_rcp_f32 v14, v14
    v_rcp_f32 v15, v15
    v_fma_f32 v100, -v100, v12, v100
    v_mfma_f32_32x32x16_bf16 v[128:143], a[28:31], a[252:255], v[128:143]
    s_waitcnt lgkmcnt(0)
    buffer_load_dwordx4 v203, s[64:67], s94 offen offset:3072 lds
    v_fma_f32 v101, -v101, v13, v101
    v_fma_f32 v102, -v102, v14, v102
    v_fma_f32 v103, -v103, v15, v103
    v_cvt_pk_bf16_f32 v98, v100, v101
    v_cvt_pk_bf16_f32 v99, v102, v103
    v_exp_f32 v8, v80
    v_exp_f32 v9, v81
    v_mfma_f32_32x32x16_bf16 v[144:159], a[0:3], a[224:227], 0
    ds_read_b64_tr_b16 a[240:241], v231 offset:32768
    ds_read_b64_tr_b16 a[242:243], v231 offset:33792
    buffer_load_dwordx2 v[180:181], v4, s[72:75], 0 offen offset:256 sc1
    v_exp_f32 v10, v82
    v_exp_f32 v11, v83
    v_fma_f32 v12, v8, 0.5, 1.0
    v_fma_f32 v13, v9, 0.5, 1.0
    v_fma_f32 v14, v10, 0.5, 1.0
    v_fma_f32 v15, v11, 0.5, 1.0
    v_mfma_f32_32x32x16_bf16 v[160:175], a[4:7], a[224:227], 0
    ds_read_b64_tr_b16 a[244:245], v231 offset:34816
    ds_read_b64_tr_b16 a[246:247], v231 offset:35840
    v_fma_f32 v12, v8, v12, 1.0
    v_fma_f32 v13, v9, v13, 1.0
    v_fma_f32 v14, v10, v14, 1.0
    v_fma_f32 v15, v11, v15, 1.0
    v_rcp_f32 v12, v12
    v_rcp_f32 v13, v13
    v_rcp_f32 v14, v14
    v_rcp_f32 v15, v15
    v_mfma_f32_32x32x16_bf16 v[144:159], a[8:11], a[228:231], v[144:159]
    s_add_u32 m0, s93, 69632
    s_add_u32 s94, s87, 129024
    buffer_load_dwordx4 v200, s[64:67], s94 offen offset:0 lds
    v_fma_f32 v80, -v80, v12, v80
    v_fma_f32 v81, -v81, v13, v81
    v_fma_f32 v82, -v82, v14, v82
    v_fma_f32 v83, -v83, v15, v83
    v_cvt_pk_bf16_f32 v80, v80, v81
    v_cvt_pk_bf16_f32 v81, v82, v83
    v_exp_f32_e64 v8, v84
    v_mfma_f32_32x32x16_bf16 v[160:175], a[12:15], a[228:231], v[160:175]
    ds_read_b64_tr_b16 a[248:249], v231 offset:36864
    ds_read_b64_tr_b16 a[250:251], v231 offset:37888
    buffer_load_dwordx2 v[178:179], v4, s[72:75], 0 offen offset:128 sc1
    v_exp_f32 v9, v85
    v_exp_f32 v10, v86
    v_exp_f32_e64 v11, v87
    v_fma_f32 v12, v8, 0.5, 1.0
    v_fma_f32 v13, v9, 0.5, 1.0
    v_fma_f32 v14, v10, 0.5, 1.0
    v_mfma_f32_32x32x16_bf16 v[144:159], a[16:19], a[232:235], v[144:159]
    ds_read_b64_tr_b16 a[252:253], v231 offset:38912
    ds_read_b64_tr_b16 a[254:255], v231 offset:39936
    buffer_load_dwordx2 v[176:177], v4, s[72:75], 0 offen offset:0 sc1
    v_fma_f32 v15, v11, 0.5, 1.0
    v_fma_f32 v12, v8, v12, 1.0
    v_fma_f32 v13, v9, v13, 1.0
    v_fma_f32 v14, v10, v14, 1.0
    v_fma_f32 v15, v11, v15, 1.0
    v_rcp_f32 v12, v12
    v_rcp_f32 v13, v13
    v_mfma_f32_32x32x16_bf16 v[160:175], a[20:23], a[232:235], v[160:175]
    buffer_load_dwordx4 v201, s[64:67], s94 offen offset:1024 lds
    ds_write_b128 v237, v[96:99] offset:1024
    v_rcp_f32 v14, v14
    v_mfma_f32_32x32x16_bf16 v[144:159], a[24:27], a[236:239], v[144:159]
    buffer_load_dwordx4 v202, s[64:67], s94 offen offset:2048 lds
    v_rcp_f32 v15, v15
    v_fma_f32 v84, -v84, v12, v84
    v_fma_f32 v85, -v85, v13, v85
    v_fma_f32 v86, -v86, v14, v86
    v_fma_f32 v87, -v87, v15, v87
    v_cvt_pk_bf16_f32 v82, v84, v85
L_page3:
    s_cbranch_execz L_back0
    s_nop 0
    v_cvt_pk_bf16_f32 v83, v86, v87
    v_exp_f32 v8, v104
    v_mfma_f32_32x32x16_bf16 v[160:175], a[28:31], a[236:239], v[160:175]
    s_waitcnt vmcnt(19) lgkmcnt(1)
    s_barrier
    buffer_load_dwordx4 v203, s[64:67], s94 offen offset:3072 lds
    v_exp_f32 v9, v105
    v_exp_f32 v10, v106
    v_exp_f32 v11, v107
    v_fma_f32 v12, v8, 0.5, 1.0
    v_fma_f32 v13, v9, 0.5, 1.0
    v_mfma_f32_32x32x16_bf16 v[48:63], a[0:3], a[240:243], 0
    ds_read_b64_tr_b16 a[224:225], v231 offset:49152
    ds_read_b64_tr_b16 a[226:227], v231 offset:50176
    v_fma_f32 v14, v10, 0.5, 1.0
    v_fma_f32 v15, v11, 0.5, 1.0
    v_fma_f32 v12, v8, v12, 1.0
    v_fma_f32 v13, v9, v13, 1.0
    v_fma_f32 v14, v10, v14, 1.0
    v_fma_f32 v15, v11, v15, 1.0
    v_rcp_f32 v12, v12
    v_rcp_f32 v13, v13
    v_rcp_f32_e64 v14, v14
    v_mfma_f32_32x32x16_bf16 v[64:79], a[4:7], a[240:243], 0
    ds_read_b64_tr_b16 a[228:229], v231 offset:51200
    ds_read_b64_tr_b16 a[230:231], v231 offset:52224
    v_rcp_f32_e64 v15, v15
    v_fma_f32 v104, -v104, v12, v104
    v_fma_f32 v105, -v105, v13, v105
    v_fma_f32 v106, -v106, v14, v106
    v_fma_f32 v107, -v107, v15, v107
    v_cvt_pk_bf16_f32 v104, v104, v105
    v_cvt_pk_bf16_f32 v105, v106, v107
    v_exp_f32 v8, v108
    v_exp_f32 v9, v109
    v_mfma_f32_32x32x16_bf16 v[48:63], a[8:11], a[244:247], v[48:63]
    s_add_u32 m0, s93, 86016
    s_mul_i32 s94, s87, 448
    buffer_load_dwordx4 v204, s[48:51], s94 offen offset:0 lds
    v_exp_f32 v10, v110
    v_exp_f32 v11, v111
    v_fma_f32 v12, v8, 0.5, 1.0
    v_fma_f32 v13, v9, 0.5, 1.0
    v_fma_f32 v14, v10, 0.5, 1.0
    v_fma_f32 v15, v11, 0.5, 1.0
    v_mfma_f32_32x32x16_bf16 v[64:79], a[12:15], a[244:247], v[64:79]
    ds_read_b64_tr_b16 a[232:233], v231 offset:53248
    ds_read_b64_tr_b16 a[234:235], v231 offset:54272
    v_fma_f32 v12, v8, v12, 1.0
    v_fma_f32 v13, v9, v13, 1.0
    v_fma_f32 v14, v10, v14, 1.0
    v_fma_f32 v15, v11, v15, 1.0
    v_rcp_f32 v12, v12
    v_rcp_f32 v13, v13
    v_rcp_f32 v14, v14
    v_rcp_f32 v15, v15
    v_mfma_f32_32x32x16_bf16 v[48:63], a[16:19], a[248:251], v[48:63]
    ds_read_b64_tr_b16 a[236:237], v231 offset:55296
    ds_read_b64_tr_b16 a[238:239], v231 offset:56320
    v_fma_f32 v108, -v108, v12, v108
    v_fma_f32 v109, -v109, v13, v109
    v_fma_f32 v110, -v110, v14, v110
    v_fma_f32 v111, -v111, v15, v111
    v_cvt_pk_bf16_f32 v106, v108, v109
    v_cvt_pk_bf16_f32 v107, v110, v111
    v_exp_f32 v8, v88
    v_exp_f32 v9, v89
    v_exp_f32_e64 v10, v90
    v_mfma_f32_32x32x16_bf16 v[64:79], a[20:23], a[248:251], v[64:79]
    buffer_load_dwordx4 v205, s[48:51], s94 offen offset:1024 lds
    ds_write_b128 v237, v[80:83] offset:0
    v_exp_f32_e64 v11, v91
    v_mfma_f32_32x32x16_bf16 v[48:63], a[24:27], a[252:255], v[48:63]
    buffer_load_dwordx4 v206, s[48:51], s94 offen offset:2048 lds
    ds_write_b128 v237, v[104:107] offset:9216
    v_fma_f32 v12, v8, 0.5, 1.0
    v_fma_f32 v13, v9, 0.5, 1.0
    v_fma_f32 v14, v10, 0.5, 1.0
    v_mfma_f32_32x32x16_bf16 v[64:79], a[28:31], a[252:255], v[64:79]
    s_waitcnt lgkmcnt(2)
    s_nop 0
    buffer_load_dwordx4 v207, s[48:51], s94 offen offset:3072 lds
    v_fma_f32 v15, v11, 0.5, 1.0
    v_fma_f32 v12, v8, v12, 1.0
    v_fma_f32 v13, v9, v13, 1.0
    v_fma_f32 v14, v10, v14, 1.0
    v_fma_f32 v15, v11, v15, 1.0
    v_rcp_f32 v12, v12
    v_rcp_f32 v13, v13
    v_mfma_f32_32x32x16_bf16 v[112:127], a[32:35], a[224:227], v[112:127]
    ds_read_b64_tr_b16 a[240:241], v230 offset:32768
    ds_read_b64_tr_b16 a[242:243], v230 offset:33792
    v_rcp_f32 v14, v14
    v_rcp_f32 v15, v15
    v_fma_f32 v88, -v88, v12, v88
    v_fma_f32 v89, -v89, v13, v89
    v_fma_f32 v90, -v90, v14, v90
    v_fma_f32 v91, -v91, v15, v91
    v_cvt_pk_bf16_f32 v88, v88, v89
    v_cvt_pk_bf16_f32 v89, v90, v91
    v_exp_f32_e64 v8, v92
    v_mfma_f32_32x32x16_bf16 v[128:143], a[36:39], a[224:227], v[128:143]
    ds_read_b64_tr_b16 a[244:245], v230 offset:34816
    ds_read_b64_tr_b16 a[246:247], v230 offset:35840
    v_and_b32 v6, 0xc0, v1
    global_load_dword v6, v6, s[32:33] sc1
    v_exp_f32 v9, v93
    v_exp_f32 v10, v94
    v_exp_f32_e64 v11, v95
    v_fma_f32 v12, v8, 0.5, 1.0
    v_mfma_f32_32x32x16_bf16 v[112:127], a[40:43], a[228:231], v[112:127]
    s_add_u32 m0, s93, 102400
    s_mul_i32 s94, s87, 448
    buffer_load_dwordx4 v204, s[52:55], s94 offen offset:0 lds
    v_fma_f32 v13, v9, 0.5, 1.0
    v_fma_f32 v14, v10, 0.5, 1.0
    v_fma_f32 v15, v11, 0.5, 1.0
    v_fma_f32 v12, v8, v12, 1.0
    v_fma_f32 v13, v9, v13, 1.0
    v_fma_f32 v14, v10, v14, 1.0
    v_fma_f32 v15, v11, v15, 1.0
    v_rcp_f32_e64 v12, v12
    v_mfma_f32_32x32x16_bf16 v[128:143], a[44:47], a[228:231], v[128:143]
    ds_read_b64_tr_b16 a[248:249], v230 offset:36864
    ds_read_b64_tr_b16 a[250:251], v230 offset:37888
    v_rcp_f32 v13, v13
    v_rcp_f32 v14, v14
    v_rcp_f32_e64 v15, v15
    v_fma_f32 v92, -v92, v12, v92
    v_fma_f32 v93, -v93, v13, v93
    v_fma_f32 v94, -v94, v14, v94
    v_fma_f32 v95, -v95, v15, v95
    v_cvt_pk_bf16_f32 v90, v92, v93
    v_cvt_pk_bf16_f32 v91, v94, v95
    v_mfma_f32_32x32x16_bf16 v[112:127], a[48:51], a[232:235], v[112:127]
    ds_read_b64_tr_b16 a[252:253], v230 offset:38912
    ds_read_b64_tr_b16 a[254:255], v230 offset:39936
    s_waitcnt vmcnt(9)
    v_fmac_f32 v188, v249, v190
    v_fmac_f32 v189, v249, v191
    v_fma_f32 v188, -v250, v191, v188
    v_fmac_f32 v189, v250, v190
    v_fmac_f32 v186, v249, v188
    v_fmac_f32 v187, v249, v189
    v_fma_f32 v186, -v250, v189, v186
    v_fmac_f32 v187, v250, v188
    v_fmac_f32 v184, v249, v186
    v_fmac_f32 v185, v249, v187
    v_fma_f32 v184, -v250, v187, v184
    v_fmac_f32 v185, v250, v186
    v_mfma_f32_32x32x16_bf16 v[128:143], a[52:55], a[232:235], v[128:143]
    buffer_load_dwordx4 v205, s[52:55], s94 offen offset:1024 lds
    ds_write_b128 v237, v[88:91] offset:8192
    v_fmac_f32 v182, v249, v184
    v_fmac_f32 v183, v249, v185
    v_mfma_f32_32x32x16_bf16 v[112:127], a[56:59], a[236:239], v[112:127]
    buffer_load_dwordx4 v206, s[52:55], s94 offen offset:2048 lds
    v_fma_f32 v182, -v250, v185, v182
    v_fmac_f32 v183, v250, v184
    v_fmac_f32 v180, v249, v182
    v_fmac_f32 v181, v249, v183
    v_fma_f32 v180, -v250, v183, v180
    v_fmac_f32 v181, v250, v182
    v_fmac_f32 v178, v249, v180
    v_fmac_f32 v179, v249, v181
    v_fma_f32 v178, -v250, v181, v178
    v_fmac_f32 v179, v250, v180
    v_fmac_f32 v176, v249, v178
    v_mfma_f32_32x32x16_bf16 v[128:143], a[60:63], a[236:239], v[128:143]
    s_waitcnt lgkmcnt(1)
    s_barrier
    buffer_load_dwordx4 v207, s[52:55], s94 offen offset:3072 lds
    v_fmac_f32 v177, v249, v179
    v_fma_f32 v176, -v250, v179, v176
    v_fmac_f32 v177, v250, v178
    v_mul_f32 v179, v252, v176
    v_mul_f32 v178, v251, v176
    v_fma_f32 v179, -v251, v177, v179
    v_fmac_f32_e64 v178, v252, v177
    v_mfma_f32_32x32x16_bf16 v[144:159], a[32:35], a[240:243], v[144:159]
    ds_read_b64_tr_b16 a[224:225], v230 offset:16384
    ds_read_b64_tr_b16 a[226:227], v230 offset:17408
    v_cmp_u_f32 vcc, v178, v179
    s_cbranch_vccnz L_carry_retry
L_carry_ok:
    v_fmac_f32_dpp v178, v179, v253 row_ror:8 row_mask:0xf bank_mask:0xf
    v_mov_b32 v179, v178
    v_xor_b32 v241, 16, v238
    v_xor_b32 v242, 64, v238
    v_permlane32_swap_b32 v178, v179
    v_add_f32 v178, v178, v179
    v_fmac_f32 v16, v245, v178
    v_fmac_f32_e64 v32, v247, v178
    v_xor_b32 v243, 0x50, v238
    v_fmac_f32_dpp v16, v178, v246 row_ror:8 row_mask:0xf bank_mask:0xf
    v_mfma_f32_32x32x16_bf16 v[160:175], a[36:39], a[240:243], v[160:175]
    ds_read_b64_tr_b16 a[228:229], v230 offset:18432
    ds_read_b64_tr_b16 a[230:231], v230 offset:19456
    v_fmac_f32_dpp v32, v178, v248 row_ror:8 row_mask:0xf bank_mask:0xf
    v_fmac_f32 v17, v239, v16
    v_fmac_f32 v33, v239, v32
    s_nop 0
    v_fmac_f32_dpp v17, v16, v240 row_ror:8 row_mask:0xf bank_mask:0xf
    v_fmac_f32_dpp v33, v32, v240 row_ror:8 row_mask:0xf bank_mask:0xf
    v_fmac_f32 v18, v239, v17
    v_fmac_f32_e64 v34, v239, v33
    v_cvt_pk_bf16_f32 v16, v16, v17
    v_fmac_f32_dpp v18, v17, v240 row_ror:8 row_mask:0xf bank_mask:0xf
    v_fmac_f32_dpp v34, v33, v240 row_ror:8 row_mask:0xf bank_mask:0xf
    v_fmac_f32 v19, v239, v18
    v_fmac_f32 v35, v239, v34
    v_mfma_f32_32x32x16_bf16 v[144:159], a[40:43], a[244:247], v[144:159]
    s_add_u32 m0, s93, 118784
    s_add_u32 s94, s88, 114688
    buffer_load_dwordx4 v200, s[64:67], s94 offen offset:0 lds
    v_cvt_pk_bf16_f32 v32, v32, v33
    v_fmac_f32_dpp v19, v18, v240 row_ror:8 row_mask:0xf bank_mask:0xf
    v_fmac_f32_dpp v35, v34, v240 row_ror:8 row_mask:0xf bank_mask:0xf
    v_fmac_f32 v20, v239, v19
    v_fmac_f32 v36, v239, v35
    v_cvt_pk_bf16_f32 v17, v18, v19
    v_fmac_f32_dpp v20, v19, v240 row_ror:8 row_mask:0xf bank_mask:0xf
    v_fmac_f32_dpp v36, v35, v240 row_ror:8 row_mask:0xf bank_mask:0xf
    v_fmac_f32_e64 v21, v239, v20
    v_mfma_f32_32x32x16_bf16 v[160:175], a[44:47], a[244:247], v[160:175]
    ds_read_b64_tr_b16 a[232:233], v230 offset:20480
    ds_read_b64_tr_b16 a[234:235], v230 offset:21504
    v_fmac_f32_e64 v37, v239, v36
    v_cvt_pk_bf16_f32 v33, v34, v35
    v_fmac_f32_dpp v21, v20, v240 row_ror:8 row_mask:0xf bank_mask:0xf
    v_fmac_f32_dpp v37, v36, v240 row_ror:8 row_mask:0xf bank_mask:0xf
    v_fmac_f32 v22, v239, v21
    v_fmac_f32 v38, v239, v37
    v_cvt_pk_bf16_f32 v18, v20, v21
    v_fmac_f32_dpp v22, v21, v240 row_ror:8 row_mask:0xf bank_mask:0xf
    v_fmac_f32_dpp v38, v37, v240 row_ror:8 row_mask:0xf bank_mask:0xf
    v_fmac_f32 v23, v239, v22
    v_fmac_f32 v39, v239, v38
    v_cvt_pk_bf16_f32 v34, v36, v37
    v_mfma_f32_32x32x16_bf16 v[144:159], a[48:51], a[248:251], v[144:159]
    ds_read_b64_tr_b16 a[236:237], v230 offset:22528
    ds_read_b64_tr_b16 a[238:239], v230 offset:23552
    v_fmac_f32_dpp v23, v22, v240 row_ror:8 row_mask:0xf bank_mask:0xf
    v_fmac_f32_dpp v39, v38, v240 row_ror:8 row_mask:0xf bank_mask:0xf
    v_fmac_f32 v24, v239, v23
    v_fmac_f32 v40, v239, v39
    v_cvt_pk_bf16_f32 v19, v22, v23
    v_fmac_f32_dpp v24, v23, v240 row_ror:8 row_mask:0xf bank_mask:0xf
    v_fmac_f32_dpp v40, v39, v240 row_ror:8 row_mask:0xf bank_mask:0xf
    v_fmac_f32 v25, v239, v24
    v_fmac_f32 v41, v239, v40
    v_cvt_pk_bf16_f32 v35, v38, v39
    v_fmac_f32_dpp v25, v24, v240 row_ror:8 row_mask:0xf bank_mask:0xf
    v_fmac_f32_dpp v41, v40, v240 row_ror:8 row_mask:0xf bank_mask:0xf
    v_mfma_f32_32x32x16_bf16 v[160:175], a[52:55], a[248:251], v[160:175]
    buffer_load_dwordx4 v201, s[64:67], s94 offen offset:1024 lds
    ds_write_b128 v238, v[16:19]
    v_mfma_f32_32x32x16_bf16 v[144:159], a[56:59], a[252:255], v[144:159]
    buffer_load_dwordx4 v202, s[64:67], s94 offen offset:2048 lds
    ds_write_b128 v242, v[32:35]
    v_mfma_f32_32x32x16_bf16 v[160:175], a[60:63], a[252:255], v[160:175]
    s_waitcnt lgkmcnt(2)
    s_barrier
    buffer_load_dwordx4 v203, s[64:67], s94 offen offset:3072 lds
    v_fmac_f32 v26, v239, v25
    v_fmac_f32 v42, v239, v41
    v_mfma_f32_32x32x16_bf16 v[48:63], a[32:35], a[224:227], v[48:63]
    ds_read_b64_tr_b16 a[240:241], v230 offset:49152
    ds_read_b64_tr_b16 a[242:243], v230 offset:50176
    ds_read_b128 a[64:67], v1 offset:0
    ds_read_b128 a[68:71], v1 offset:1024
    v_cvt_pk_bf16_f32 v24, v24, v25
    v_fmac_f32_dpp v26, v25, v240 row_ror:8 row_mask:0xf bank_mask:0xf
    v_fmac_f32_dpp v42, v41, v240 row_ror:8 row_mask:0xf bank_mask:0xf
    v_fmac_f32 v27, v239, v26
    v_fmac_f32 v43, v239, v42
    v_cvt_pk_bf16_f32 v40, v40, v41
    v_mfma_f32_32x32x16_bf16 v[64:79], a[36:39], a[224:227], v[64:79]
    ds_read_b64_tr_b16 a[244:245], v230 offset:51200
    ds_read_b64_tr_b16 a[246:247], v230 offset:52224
    ds_read_b128 a[72:75], v1 offset:2048
    v_fmac_f32_dpp v27, v26, v240 row_ror:8 row_mask:0xf bank_mask:0xf
    v_fmac_f32_dpp v43, v42, v240 row_ror:8 row_mask:0xf bank_mask:0xf
    v_fmac_f32 v28, v239, v27
    v_fmac_f32 v44, v239, v43
    v_cvt_pk_bf16_f32 v25, v26, v27
    v_fmac_f32_dpp v28, v27, v240 row_ror:8 row_mask:0xf bank_mask:0xf
    v_fmac_f32_dpp v44, v43, v240 row_ror:8 row_mask:0xf bank_mask:0xf
    v_mfma_f32_32x32x16_bf16 v[48:63], a[40:43], a[228:231], v[48:63]
    ds_read_b128 a[76:79], v1 offset:3072
    ds_read_b64_tr_b16 a[248:249], v230 offset:53248
    ds_read_b64_tr_b16 a[250:251], v230 offset:54272
    ds_read_b128 a[80:83], v1 offset:4096
    v_fmac_f32 v29, v239, v28
    v_fmac_f32 v45, v239, v44
    v_cvt_pk_bf16_f32 v41, v42, v43
    v_fmac_f32_dpp v29, v28, v240 row_ror:8 row_mask:0xf bank_mask:0xf
    v_fmac_f32_dpp v45, v44, v240 row_ror:8 row_mask:0xf bank_mask:0xf
    v_fmac_f32_e64 v30, v239, v29
    v_mfma_f32_32x32x16_bf16 v[64:79], a[44:47], a[228:231], v[64:79]
    ds_read_b128 a[84:87], v1 offset:5120
    ds_read_b64_tr_b16 a[252:253], v230 offset:55296
    ds_read_b64_tr_b16 a[254:255], v230 offset:56320
    v_fmac_f32_e64 v46, v239, v45
    v_cvt_pk_bf16_f32 v26, v28, v29
    v_fmac_f32_dpp v30, v29, v240 row_ror:8 row_mask:0xf bank_mask:0xf
    v_fmac_f32_dpp v46, v45, v240 row_ror:8 row_mask:0xf bank_mask:0xf
    v_fmac_f32 v31, v239, v30
    v_fmac_f32 v47, v239, v46
    v_cvt_pk_bf16_f32 v42, v44, v45
    v_mfma_f32_32x32x16_bf16 v[48:63], a[48:51], a[232:235], v[48:63]
    ds_read_b128 a[88:91], v1 offset:6144
    ds_read_b128 a[92:95], v1 offset:7168
    s_add_u32 m0, s93, 36864
    s_add_u32 s94, s88, 129024
    buffer_load_dwordx4 v200, s[64:67], s94 offen offset:0 lds
    v_fmac_f32_dpp v31, v30, v240 row_ror:8 row_mask:0xf bank_mask:0xf
    v_fmac_f32_dpp v47, v46, v240 row_ror:8 row_mask:0xf bank_mask:0xf
    v_cvt_pk_bf16_f32 v27, v30, v31
    v_cvt_pk_bf16_f32 v43, v46, v47
    v_mfma_f32_32x32x16_bf16 v[64:79], a[52:55], a[232:235], v[64:79]
    buffer_load_dwordx4 v201, s[64:67], s94 offen offset:1024 lds
    ds_write_b128 v241, v[24:27]
    v_mfma_f32_32x32x16_bf16 v[48:63], a[56:59], a[236:239], v[48:63]
    buffer_load_dwordx4 v202, s[64:67], s94 offen offset:2048 lds
    ds_write_b128 v243, v[40:43]
    v_mfma_f32_32x32x16_bf16 v[64:79], a[60:63], a[236:239], v[64:79]
    s_waitcnt vmcnt(16) lgkmcnt(2)
    s_barrier
    buffer_load_dwordx4 v203, s[64:67], s94 offen offset:3072 lds
    v_mfma_f32_32x32x16_bf16 v[112:127], a[64:67], a[240:243], v[112:127]
    ds_read_b64_tr_b16 a[224:225], v231 offset:0
    ds_read_b64_tr_b16 a[226:227], v231 offset:1024
    ds_read_b64_tr_b16 a[228:229], v231 offset:2048
    ds_read_b64_tr_b16 a[230:231], v231 offset:3072
    v_mfma_f32_32x32x16_bf16 v[128:143], a[68:71], a[240:243], v[128:143]
    ds_read_b64_tr_b16 a[232:233], v231 offset:4096
    ds_read_b64_tr_b16 a[234:235], v231 offset:5120
    ds_read_b64_tr_b16 a[236:237], v231 offset:6144
    ds_read_b64_tr_b16 a[238:239], v231 offset:7168
    s_waitcnt vmcnt(12)
    v_lshrrev_b32 v218, 9, v6
    v_cmp_eq_u32 s[96:97], 0, v218
    v_nop_e64
    s_cmp_lg_u64 s[96:97], 0
    s_cbranch_scc1 L_ready_n
L_ready_n_ok:
    v_mfma_f32_32x32x16_bf16 v[112:127], a[72:75], a[244:247], v[112:127]
    ds_read_b128 a[96:99], v1 offset:8192
    ds_read_b128 a[100:103], v1 offset:9216
    v_readlane_b32 s101, v6, 0
    v_readlane_b32 s23, v6, 4
    v_mfma_f32_32x32x16_bf16 v[128:143], a[76:79], a[244:247], v[128:143]
    ds_read_b128 a[104:107], v1 offset:10240
    s_add_u32 m0, s93, 20480
    s_mul_i32 s94, s88, 448
    buffer_load_dwordx4 v204, s[48:51], s94 offen offset:0 lds
    v_mfma_f32_32x32x16_bf16 v[112:127], a[80:83], a[248:251], v[112:127]
    ds_read_b128 a[108:111], v1 offset:11264
    ds_read_b128 a[112:115], v1 offset:12288
    buffer_load_dwordx4 v205, s[48:51], s94 offen offset:1024 lds
    v_mfma_f32_32x32x16_bf16 v[128:143], a[84:87], a[248:251], v[128:143]
    ds_read_b128 a[116:119], v1 offset:13312
    ds_read_b128 a[120:123], v1 offset:14336
    v_readlane_b32 s45, v6, 8
    v_readlane_b32 s44, v6, 12
    v_mfma_f32_32x32x16_bf16 v[112:127], a[88:91], a[252:255], v[112:127]
    ds_read_b128 a[124:127], v1 offset:15360
    buffer_load_dwordx4 v206, s[48:51], s94 offen offset:2048 lds
    s_or_b32 s101, s101, s23
    s_or_b32 s44, s44, s45
    v_mfma_f32_32x32x16_bf16 v[128:143], a[92:95], a[252:255], v[128:143]
    s_waitcnt vmcnt(11) lgkmcnt(3)
    s_barrier
    buffer_load_dwordx4 v207, s[48:51], s94 offen offset:3072 lds
    v_mfma_f32_32x32x16_bf16 v[112:127], a[96:99], a[224:227], v[112:127]
    ds_read_b128 a[240:243], v224 offset:16384
    ds_read_b128 a[244:247], v225 offset:16384
    s_add_u32 m0, s93, 53248
    s_mul_i32 s94, s88, 448
    buffer_load_dwordx4 v204, s[52:55], s94 offen offset:0 lds
    v_mfma_f32_32x32x16_bf16 v[128:143], a[100:103], a[224:227], v[128:143]
    ds_read_b128 a[248:251], v226 offset:16384
    ds_read_b128 a[252:255], v227 offset:16384
    buffer_load_dwordx4 v205, s[52:55], s94 offen offset:1024 lds
    v_mfma_f32_32x32x16_bf16 v[112:127], a[104:107], a[228:231], v[112:127]
    ds_read_b64_tr_b16 a[128:129], v232 offset:0
    ds_read_b64_tr_b16 a[130:131], v234 offset:512
    ds_read_b64_tr_b16 a[132:133], v233 offset:0
    ds_read_b64_tr_b16 a[134:135], v235 offset:512
    v_mfma_f32_32x32x16_bf16 v[128:143], a[108:111], a[228:231], v[128:143]
    ds_read_b64_tr_b16 a[136:137], v232 offset:2048
    ds_read_b64_tr_b16 a[138:139], v234 offset:2560
    buffer_load_dwordx4 v206, s[52:55], s94 offen offset:2048 lds
    v_mfma_f32_32x32x16_bf16 v[112:127], a[112:115], a[232:235], v[112:127]
    ds_read_b64_tr_b16 a[140:141], v233 offset:2048
    ds_read_b64_tr_b16 a[142:143], v235 offset:2560
    ds_read_b64_tr_b16 a[144:145], v232 offset:4096
    ds_read_b64_tr_b16 a[146:147], v234 offset:4608
    s_waitcnt lgkmcnt(15)
    s_nop 0
    v_mfma_f32_32x32x16_bf16 v[128:143], a[116:119], a[232:235], v[128:143]
    ds_read_b64_tr_b16 a[148:149], v233 offset:4096
    ds_read_b64_tr_b16 a[150:151], v235 offset:4608
    ds_read_b64_tr_b16 a[152:153], v232 offset:6144
    ds_read_b64_tr_b16 a[154:155], v234 offset:6656
    v_mfma_f32_32x32x16_bf16 v[112:127], a[120:123], a[236:239], v[112:127]
    ds_read_b64_tr_b16 a[156:157], v233 offset:6144
    ds_read_b64_tr_b16 a[158:159], v235 offset:6656
    s_or_b32 s44, s44, s101
    s_bfe_i32 s23, s92, 0x10004
    s_xor_b32 s44, s44, s23
    s_lshl_b32 s44, s44, 13
    s_waitcnt lgkmcnt(15)
    v_mfma_f32_32x32x16_bf16 v[128:143], a[124:127], a[236:239], v[128:143]
    s_waitcnt lgkmcnt(6)
    buffer_load_dwordx4 v207, s[52:55], s94 offen offset:3072 lds
    s_bfe_u32 s23, s92, 0x10003
    s_lshr_b32 s45, s44, s23
    v_mfma_f32_32x32x16_bf16 v[112:127], a[128:131], a[240:243], v[112:127]
    ds_read_b128 a[224:227], v224 offset:32768
    ds_read_b128 a[228:231], v225 offset:32768
    s_add_u32 m0, s93, 69632
    s_add_u32 s94, s89, 114688
    buffer_load_dwordx4 v200, s[64:67], s94 offen offset:0 lds
    v_mfma_f32_32x32x16_bf16 v[128:143], a[132:135], a[240:243], v[128:143]
    ds_read_b128 a[232:235], v226 offset:32768
    ds_read_b128 a[236:239], v227 offset:32768
    buffer_load_dwordx4 v201, s[64:67], s94 offen offset:1024 lds
    v_mfma_f32_32x32x16_bf16 v[112:127], a[136:139], a[244:247], v[112:127]
    ds_read_b64_tr_b16 a[160:161], v232 offset:8192
    ds_read_b64_tr_b16 a[162:163], v234 offset:8704
    ds_read_b64_tr_b16 a[164:165], v233 offset:8192
    ds_read_b64_tr_b16 a[166:167], v235 offset:8704
    v_mfma_f32_32x32x16_bf16 v[128:143], a[140:143], a[244:247], v[128:143]
    ds_read_b64_tr_b16 a[168:169], v232 offset:10240
    ds_read_b64_tr_b16 a[170:171], v234 offset:10752
    buffer_load_dwordx4 v202, s[64:67], s94 offen offset:2048 lds
    v_mfma_f32_32x32x16_bf16 v[112:127], a[144:147], a[248:251], v[112:127]
    ds_read_b64_tr_b16 a[172:173], v233 offset:10240
    ds_read_b64_tr_b16 a[174:175], v235 offset:10752
    ds_read_b64_tr_b16 a[176:177], v232 offset:12288
    ds_read_b64_tr_b16 a[178:179], v234 offset:12800
    s_waitcnt lgkmcnt(15)
    v_mfma_f32_32x32x16_bf16 v[128:143], a[148:151], a[248:251], v[128:143]
    ds_read_b64_tr_b16 a[180:181], v233 offset:12288
    ds_read_b64_tr_b16 a[182:183], v235 offset:12800
    ds_read_b64_tr_b16 a[184:185], v232 offset:14336
    ds_read_b64_tr_b16 a[186:187], v234 offset:14848
    s_lshr_b32 s23, s45, 1
    s_and_b32 s23, s23, 0x2000
    v_mfma_f32_32x32x16_bf16 v[112:127], a[152:155], a[252:255], v[112:127]
    ds_read_b64_tr_b16 a[188:189], v233 offset:14336
    ds_read_b64_tr_b16 a[190:191], v235 offset:14848
    buffer_load_dwordx4 v203, s[64:67], s94 offen offset:3072 lds
    s_waitcnt lgkmcnt(15)
    v_mfma_f32_32x32x16_bf16 v[128:143], a[156:159], a[252:255], v[128:143]
    s_waitcnt vmcnt(12) lgkmcnt(6)
    s_barrier
    s_add_u32 s6, s6, s23
    s_add_u32 s9, s9, s23
    v_mfma_f32_32x32x16_bf16 v[112:127], a[160:163], a[224:227], v[112:127]
    ds_read_b64_tr_b16 a[240:241], v231 offset:49152
    ds_read_b64_tr_b16 a[242:243], v231 offset:50176
    s_lshr_b32 s23, s45, 3
    s_and_b32 s23, s23, 0x2000
    s_add_u32 s7, s7, s23
    s_add_u32 s10, s10, s23
    s_lshr_b32 s23, s45, 5
    v_mfma_f32_32x32x16_bf16 v[112:127], a[168:171], a[228:231], v[112:127]
    ds_read_b64_tr_b16 a[244:245], v231 offset:51200
    ds_read_b64_tr_b16 a[246:247], v231 offset:52224
    s_and_b32 s23, s23, 0x2000
    s_add_u32 s8, s8, s23
    s_add_u32 s11, s11, s23
    s_and_b32 s23, s44, 0x2000
    v_mfma_f32_32x32x16_bf16 v[112:127], a[176:179], a[232:235], v[112:127]
    s_add_u32 m0, s93, 86016
    s_add_u32 s94, s89, 129024
    buffer_load_dwordx4 v200, s[64:67], s94 offen offset:0 lds
    v_add_u32_e64 v254, s23, v254
    s_waitcnt lgkmcnt(6)
    v_mfma_f32_32x32x16_bf16 v[112:127], a[184:187], a[236:239], v[112:127]
    ds_read_b64_tr_b16 a[248:249], v231 offset:53248
    ds_read_b64_tr_b16 a[250:251], v231 offset:54272
    s_add_u32 s12, s12, s23
    s_add_u32 s26, s26, s23
    s_add_u32 s27, s27, s23
    v_mfma_f32_32x32x16_bf16 v[128:143], a[164:167], a[224:227], v[128:143]
    ds_read_b64_tr_b16 a[252:253], v231 offset:55296
    ds_read_b64_tr_b16 a[254:255], v231 offset:56320
    v_mfma_f32_32x32x16_bf16 v[128:143], a[172:175], a[228:231], v[128:143]
    buffer_load_dwordx4 v201, s[64:67], s94 offen offset:1024 lds
    s_nop 1
    v_cvt_pk_bf16_f32 v112, v112, v113
    v_cvt_pk_bf16_f32 v113, v114, v115
    v_mfma_f32_32x32x16_bf16 v[128:143], a[180:183], a[232:235], v[128:143]
    buffer_load_dwordx4 v202, s[64:67], s94 offen offset:2048 lds
    v_cvt_pk_bf16_f32 v114, v116, v117
    v_cvt_pk_bf16_f32 v115, v118, v119
    s_waitcnt lgkmcnt(8)
    v_mfma_f32_32x32x16_bf16 v[128:143], a[188:191], a[236:239], v[128:143]
    s_waitcnt lgkmcnt(0)
    buffer_load_dwordx4 v203, s[64:67], s94 offen offset:3072 lds
    v_mfma_f32_32x32x16_bf16 v[144:159], a[64:67], a[240:243], v[144:159]
    ds_read_b64_tr_b16 a[224:225], v230 offset:32768
    ds_read_b64_tr_b16 a[226:227], v230 offset:33792
    buffer_store_dwordx4 v[112:115], v1, s[76:79], s6 offen offset:0 sc1
    v_mfma_f32_32x32x16_bf16 v[160:175], a[68:71], a[240:243], v[160:175]
    ds_read_b64_tr_b16 a[228:229], v230 offset:34816
    ds_read_b64_tr_b16 a[230:231], v230 offset:35840
    v_cvt_pk_bf16_f32 v120, v120, v121
    v_cvt_pk_bf16_f32 v121, v122, v123
    v_cvt_pk_bf16_f32 v122, v124, v125
    v_mfma_f32_32x32x16_bf16 v[144:159], a[72:75], a[244:247], v[144:159]
    s_add_u32 m0, s93, 102400
    s_mul_i32 s94, s89, 448
    buffer_load_dwordx4 v204, s[48:51], s94 offen offset:0 lds
    v_cvt_pk_bf16_f32 v123, v126, v127
    v_mfma_f32_32x32x16_bf16 v[160:175], a[76:79], a[244:247], v[160:175]
    ds_read_b64_tr_b16 a[232:233], v230 offset:36864
    ds_read_b64_tr_b16 a[234:235], v230 offset:37888
    buffer_store_dwordx4 v[120:123], v1, s[76:79], s6 offen offset:1024 sc1
    v_mfma_f32_32x32x16_bf16 v[144:159], a[80:83], a[248:251], v[144:159]
    ds_read_b64_tr_b16 a[236:237], v230 offset:38912
    ds_read_b64_tr_b16 a[238:239], v230 offset:39936
    v_cvt_pk_bf16_f32 v128, v128, v129
    v_cvt_pk_bf16_f32 v129, v130, v131
    v_cvt_pk_bf16_f32 v130, v132, v133
    v_mfma_f32_32x32x16_bf16 v[160:175], a[84:87], a[248:251], v[160:175]
    buffer_load_dwordx4 v205, s[48:51], s94 offen offset:1024 lds
    v_cvt_pk_bf16_f32 v131, v134, v135
    v_mfma_f32_32x32x16_bf16 v[144:159], a[88:91], a[252:255], v[144:159]
    buffer_load_dwordx4 v206, s[48:51], s94 offen offset:2048 lds
    v_mfma_f32_32x32x16_bf16 v[160:175], a[92:95], a[252:255], v[160:175]
    s_waitcnt vmcnt(17) lgkmcnt(0)
    s_barrier
    buffer_load_dwordx4 v207, s[48:51], s94 offen offset:3072 lds
    v_mfma_f32_32x32x16_bf16 v[144:159], a[96:99], a[224:227], v[144:159]
    ds_read_b128 a[240:243], v220 offset:16384
    buffer_store_dwordx4 v[128:131], v1, s[76:79], s6 offen offset:2048 sc1
    v_mfma_f32_32x32x16_bf16 v[160:175], a[100:103], a[224:227], v[160:175]
    ds_read_b128 a[244:247], v221 offset:16384
    v_cvt_pk_bf16_f32 v136, v136, v137
    v_cvt_pk_bf16_f32 v137, v138, v139
    v_cvt_pk_bf16_f32 v138, v140, v141
    v_cvt_pk_bf16_f32 v139, v142, v143
    v_mfma_f32_32x32x16_bf16 v[144:159], a[104:107], a[228:231], v[144:159]
    s_add_u32 m0, s93, 118784
    s_mul_i32 s94, s89, 448
    buffer_load_dwordx4 v204, s[52:55], s94 offen offset:0 lds
    v_mfma_f32_32x32x16_bf16 v[160:175], a[108:111], a[228:231], v[160:175]
    ds_read_b128 a[248:251], v222 offset:16384
    buffer_store_dwordx4 v[136:139], v1, s[76:79], s6 offen offset:3072 sc1
    v_mfma_f32_32x32x16_bf16 v[144:159], a[112:115], a[232:235], v[144:159]
    ds_read_b128 a[252:255], v223 offset:16384
    v_mfma_f32_32x32x16_bf16 v[160:175], a[116:119], a[232:235], v[160:175]
    buffer_load_dwordx4 v205, s[52:55], s94 offen offset:1024 lds
    v_mfma_f32_32x32x16_bf16 v[144:159], a[120:123], a[236:239], v[144:159]
    buffer_load_dwordx4 v206, s[52:55], s94 offen offset:2048 lds
    v_mfma_f32_32x32x16_bf16 v[160:175], a[124:127], a[236:239], v[160:175]
    s_waitcnt vmcnt(19) lgkmcnt(0)
    s_nop 0
    buffer_load_dwordx4 v207, s[52:55], s94 offen offset:3072 lds
    v_mfma_f32_32x32x16_bf16 v[144:159], a[128:131], a[240:243], v[144:159]
    ds_read_b128 a[224:227], v220 offset:49152
    v_mfma_f32_32x32x16_bf16 v[160:175], a[132:135], a[240:243], v[160:175]
    ds_read_b128 a[228:231], v221 offset:49152
    v_mfma_f32_32x32x16_bf16 v[144:159], a[136:139], a[244:247], v[144:159]
    s_add_u32 m0, s93, 36864
    s_add_u32 s94, s4, 0
    s_nop 0
    buffer_load_dwordx4 v200, s[64:67], s94 offen offset:0 lds
    v_mfma_f32_32x32x16_bf16 v[160:175], a[140:143], a[244:247], v[160:175]
    ds_read_b128 a[232:235], v222 offset:49152
    v_mfma_f32_32x32x16_bf16 v[144:159], a[144:147], a[248:251], v[144:159]
    ds_read_b128 a[236:239], v223 offset:49152
    v_mfma_f32_32x32x16_bf16 v[160:175], a[148:151], a[248:251], v[160:175]
    buffer_load_dwordx4 v201, s[64:67], s94 offen offset:1024 lds
    v_mfma_f32_32x32x16_bf16 v[144:159], a[152:155], a[252:255], v[144:159]
L_page4:
    s_cbranch_execz L_back0
    s_nop 0
    buffer_load_dwordx4 v202, s[64:67], s94 offen offset:2048 lds
    v_mfma_f32_32x32x16_bf16 v[160:175], a[156:159], a[252:255], v[160:175]
    s_waitcnt vmcnt(15) lgkmcnt(0)
    s_barrier
    buffer_load_dwordx4 v203, s[64:67], s94 offen offset:3072 lds
    v_mfma_f32_32x32x16_bf16 v[144:159], a[160:163], a[224:227], v[144:159]
    ds_read_b64_tr_b16 a[240:241], v231 offset:0
    ds_read_b64_tr_b16 a[242:243], v231 offset:1024
    v_mfma_f32_32x32x16_bf16 v[144:159], a[168:171], a[228:231], v[144:159]
    ds_read_b64_tr_b16 a[244:245], v231 offset:2048
    ds_read_b64_tr_b16 a[246:247], v231 offset:3072
    v_mfma_f32_32x32x16_bf16 v[144:159], a[176:179], a[232:235], v[144:159]
    s_add_u32 m0, s93, 20480
    s_add_u32 s94, s4, 114688
    buffer_load_dwordx4 v200, s[64:67], s94 offen offset:0 lds
    v_mfma_f32_32x32x16_bf16 v[144:159], a[184:187], a[236:239], v[144:159]
    ds_read_b64_tr_b16 a[248:249], v231 offset:4096
    ds_read_b64_tr_b16 a[250:251], v231 offset:5120
    v_mfma_f32_32x32x16_bf16 v[160:175], a[164:167], a[224:227], v[160:175]
    ds_read_b64_tr_b16 a[252:253], v231 offset:6144
    ds_read_b64_tr_b16 a[254:255], v231 offset:7168
    v_mfma_f32_32x32x16_bf16 v[160:175], a[172:175], a[228:231], v[160:175]
    buffer_load_dwordx4 v201, s[64:67], s94 offen offset:1024 lds
    s_nop 4
    s_nop 0
    v_cvt_pk_bf16_f32 v144, v144, v145
    v_cvt_pk_bf16_f32 v145, v146, v147
    v_mfma_f32_32x32x16_bf16 v[160:175], a[180:183], a[232:235], v[160:175]
    buffer_load_dwordx4 v202, s[64:67], s94 offen offset:2048 lds
    v_cvt_pk_bf16_f32 v146, v148, v149
    v_mfma_f32_32x32x16_bf16 v[160:175], a[188:191], a[236:239], v[160:175]
    s_waitcnt lgkmcnt(0)
    s_nop 0
    buffer_load_dwordx4 v203, s[64:67], s94 offen offset:3072 lds
    v_cvt_pk_bf16_f32 v147, v150, v151
    v_mfma_f32_32x32x16_bf16 v[48:63], a[64:67], a[240:243], v[48:63]
    ds_read_b64_tr_b16 a[224:225], v231 offset:16384
    ds_read_b64_tr_b16 a[226:227], v231 offset:17408
    buffer_store_dwordx4 v[144:147], v1, s[76:79], s7 offen offset:0 sc1
    v_mfma_f32_32x32x16_bf16 v[64:79], a[68:71], a[240:243], v[64:79]
    ds_read_b64_tr_b16 a[228:229], v231 offset:18432
    ds_read_b64_tr_b16 a[230:231], v231 offset:19456
    v_cvt_pk_bf16_f32 v152, v152, v153
    v_cvt_pk_bf16_f32 v153, v154, v155
    v_cvt_pk_bf16_f32 v154, v156, v157
    v_mfma_f32_32x32x16_bf16 v[48:63], a[72:75], a[244:247], v[48:63]
    s_add_u32 m0, s93, 53248
    v_nop_e64
    buffer_load_dwordx4 v204, s[56:59], s5 offen offset:0 lds
    v_cvt_pk_bf16_f32 v155, v158, v159
    v_mfma_f32_32x32x16_bf16 v[64:79], a[76:79], a[244:247], v[64:79]
    ds_read_b64_tr_b16 a[232:233], v231 offset:20480
    ds_read_b64_tr_b16 a[234:235], v231 offset:21504
    buffer_store_dwordx4 v[152:155], v1, s[76:79], s7 offen offset:1024 sc1
    v_mfma_f32_32x32x16_bf16 v[48:63], a[80:83], a[248:251], v[48:63]
    ds_read_b64_tr_b16 a[236:237], v231 offset:22528
    ds_read_b64_tr_b16 a[238:239], v231 offset:23552
    v_cvt_pk_bf16_f32 v160, v160, v161
    v_cvt_pk_bf16_f32 v161, v162, v163
    v_mfma_f32_32x32x16_bf16 v[64:79], a[84:87], a[248:251], v[64:79]
    buffer_load_dwordx4 v205, s[56:59], s5 offen offset:1024 lds
    v_cvt_pk_bf16_f32 v162, v164, v165
    v_mfma_f32_32x32x16_bf16 v[48:63], a[88:91], a[252:255], v[48:63]
    buffer_load_dwordx4 v206, s[56:59], s5 offen offset:2048 lds
    s_waitcnt vmcnt(16)
    buffer_store_dwordx4 v[2:5], v229, s[76:79], s12 offen sc1
    v_mfma_f32_32x32x16_bf16 v[64:79], a[92:95], a[252:255], v[64:79]
    s_waitcnt lgkmcnt(0)
    buffer_load_dwordx4 v207, s[56:59], s5 offen offset:3072 lds
    v_mfma_f32_32x32x16_bf16 v[48:63], a[96:99], a[224:227], v[48:63]
    ds_read_b128 a[240:243], v224 offset:32768
    v_cvt_pk_bf16_f32 v163, v166, v167
    v_mfma_f32_32x32x16_bf16 v[64:79], a[100:103], a[224:227], v[64:79]
    ds_read_b128 a[244:247], v225 offset:32768
    buffer_store_dwordx4 v[160:163], v1, s[76:79], s7 offen offset:2048 sc1
    v_mfma_f32_32x32x16_bf16 v[48:63], a[104:107], a[228:231], v[48:63]
    v_cvt_pk_bf16_f32 v168, v168, v169
    v_cvt_pk_bf16_f32 v169, v170, v171
    v_cvt_pk_bf16_f32 v170, v172, v173
    v_cvt_pk_bf16_f32 v171, v174, v175
    v_mfma_f32_32x32x16_bf16 v[64:79], a[108:111], a[228:231], v[64:79]
    ds_read_b128 a[248:251], v226 offset:32768
    buffer_store_dwordx4 v[168:171], v1, s[76:79], s7 offen offset:3072 sc1
    v_mfma_f32_32x32x16_bf16 v[48:63], a[112:115], a[232:235], v[48:63]
    ds_read_b128 a[252:255], v227 offset:32768
    v_mfma_f32_32x32x16_bf16 v[64:79], a[116:119], a[232:235], v[64:79]
    s_lshl_b32 s98, s90, 12
    s_and_b32 s98, s98, 0x2000
    s_lshr_b32 s99, s98, 7
    v_subrev_u32 v212, s98, v230
    v_subrev_u32 v213, s98, v230
    v_mfma_f32_32x32x16_bf16 v[48:63], a[120:123], a[236:239], v[48:63]
    v_subrev_u32 v196, s98, v220
    v_subrev_u32 v197, s98, v221
    v_subrev_u32 v198, s98, v222
    v_subrev_u32 v199, s98, v223
    v_mfma_f32_32x32x16_bf16 v[64:79], a[124:127], a[236:239], v[64:79]
    s_waitcnt vmcnt(17) lgkmcnt(0)
    v_xor_b32 v232, s99, v232
    v_xor_b32 v234, s99, v234
    v_mfma_f32_32x32x16_bf16 v[48:63], a[128:131], a[240:243], v[48:63]
    ds_read_b128 a[224:227], v224 offset:49152
    v_lshlrev_b32 v176, 16, v192
    v_and_b32 v177, 0xffff0000, v192
    v_mfma_f32_32x32x16_bf16 v[64:79], a[132:135], a[240:243], v[64:79]
    ds_read_b128 a[228:231], v225 offset:49152
    v_lshlrev_b32 v178, 16, v193
    v_and_b32 v179, 0xffff0000, v193
    v_mfma_f32_32x32x16_bf16 v[48:63], a[136:139], a[244:247], v[48:63]
    v_lshlrev_b32 v180, 16, v194
    v_and_b32 v181, 0xffff0000, v194
    v_mfma_f32_32x32x16_bf16 v[64:79], a[140:143], a[244:247], v[64:79]
    ds_read_b128 a[232:235], v226 offset:49152
    v_lshlrev_b32_e64 v182, 16, v195
    v_and_b32 v183, 0xffff0000, v195
    v_mfma_f32_32x32x16_bf16 v[48:63], a[144:147], a[248:251], v[48:63]
    ds_read_b128 a[236:239], v227 offset:49152
    v_lshlrev_b32 v184, 16, v208
    v_and_b32 v185, 0xffff0000, v208
    v_mfma_f32_32x32x16_bf16 v[64:79], a[148:151], a[248:251], v[64:79]
    v_lshlrev_b32 v186, 16, v209
    v_and_b32 v187, 0xffff0000, v209
    v_lshlrev_b32 v188, 16, v210
    v_mfma_f32_32x32x16_bf16 v[48:63], a[152:155], a[252:255], v[48:63]
    v_and_b32 v189, 0xffff0000, v210
    v_lshlrev_b32 v190, 16, v211
    v_and_b32 v191, 0xffff0000, v211
    v_mfma_f32_32x32x16_bf16 v[64:79], a[156:159], a[252:255], v[64:79]
    s_waitcnt vmcnt(9) lgkmcnt(0)
    s_barrier
    v_mfma_f32_32x32x16_bf16 v[48:63], a[160:163], a[224:227], v[48:63]
    ds_read_b64_tr_b16 a[0:1], v212 offset:32768
    ds_read_b64_tr_b16 a[2:3], v212 offset:33792
    ds_read_b128 a[192:195], v236 offset:32768
    ds_read_b64_tr_b16 a[4:5], v212 offset:34816
    ds_read_b64_tr_b16 a[6:7], v212 offset:35840
    s_waitcnt vmcnt(0)
    s_nop 0
    buffer_store_dwordx4 v[2:5], v229, s[76:79], s26 offen sc1
    v_mfma_f32_32x32x16_bf16 v[48:63], a[168:171], a[228:231], v[48:63]
    ds_read_b128 a[196:199], v236 offset:34816
    ds_read_b64_tr_b16 a[8:9], v212 offset:36864
    ds_read_b64_tr_b16 a[10:11], v212 offset:37888
    ds_read_b128 a[200:203], v236 offset:36864
    v_mfma_f32_32x32x16_bf16 v[48:63], a[176:179], a[232:235], v[48:63]
    ds_read_b64_tr_b16 a[12:13], v212 offset:38912
    ds_read_b64_tr_b16 a[14:15], v212 offset:39936
    ds_read_b128 a[204:207], v236 offset:38912
    v_mfma_f32_32x32x16_bf16 v[48:63], a[184:187], a[236:239], v[48:63]
    ds_read_b64_tr_b16 a[16:17], v212 offset:40960
    ds_read_b64_tr_b16 a[18:19], v212 offset:41984
    ds_read_b128 a[208:211], v236 offset:40960
    ds_read_b64_tr_b16 a[20:21], v212 offset:43008
    ds_read_b64_tr_b16 a[22:23], v212 offset:44032
    v_mfma_f32_32x32x16_bf16 v[64:79], a[164:167], a[224:227], v[64:79]
    ds_read_b128 a[212:215], v236 offset:43008
    ds_read_b64_tr_b16 a[24:25], v212 offset:45056
    ds_read_b64_tr_b16 a[26:27], v212 offset:46080
    ds_read_b128 a[216:219], v236 offset:45056
    buffer_load_dword v6, v254, s[76:79], 0 offen offset:0 sc1
    v_mfma_f32_32x32x16_bf16 v[64:79], a[172:175], a[228:231], v[64:79]
    ds_read_b64_tr_b16 a[28:29], v212 offset:47104
    ds_read_b64_tr_b16 a[30:31], v212 offset:48128
    ds_read_b128 a[220:223], v236 offset:47104
    v_cvt_pk_bf16_f32 v48, v48, v49
    v_cvt_pk_bf16_f32 v49, v50, v51
    v_cvt_pk_bf16_f32 v50, v52, v53
    v_cvt_pk_bf16_f32 v51, v54, v55
    v_mfma_f32_32x32x16_bf16 v[64:79], a[180:183], a[232:235], v[64:79]
    buffer_store_dwordx4 v[48:51], v1, s[76:79], s8 offen offset:0 sc1
    v_cvt_pk_bf16_f32 v56, v56, v57
    v_cvt_pk_bf16_f32 v57, v58, v59
    v_cvt_pk_bf16_f32 v58, v60, v61
    v_mfma_f32_32x32x16_bf16 v[64:79], a[188:191], a[236:239], v[64:79]
    s_waitcnt lgkmcnt(0)
    s_nop 0
    v_cvt_pk_bf16_f32 v59, v62, v63
    v_mfma_f32_32x32x16_bf16 v[176:191], a[192:195], a[0:3], v[176:191]
    ds_read_b64_tr_b16 a[64:65], v213 offset:16384
    ds_read_b64_tr_b16 a[66:67], v213 offset:17408
    ds_read_b128 a[32:35], v236 offset:0
    ds_read_b64_tr_b16 a[68:69], v213 offset:18432
    ds_read_b64_tr_b16 a[70:71], v213 offset:19456
    buffer_store_dwordx4 v[56:59], v1, s[76:79], s8 offen offset:1024 sc1
    v_mfma_f32_32x32x16_bf16 v[176:191], a[196:199], a[4:7], v[176:191]
    ds_read_b128 a[36:39], v236 offset:2048
    ds_read_b64_tr_b16 a[72:73], v213 offset:20480
    ds_read_b64_tr_b16 a[74:75], v213 offset:21504
    ds_read_b128 a[40:43], v236 offset:4096
    v_cvt_pk_bf16_f32 v64, v64, v65
    v_cvt_pk_bf16_f32 v65, v66, v67
    v_cvt_pk_bf16_f32 v66, v68, v69
    v_cvt_pk_bf16_f32 v67, v70, v71
    v_mfma_f32_32x32x16_bf16 v[176:191], a[200:203], a[8:11], v[176:191]
    ds_read_b64_tr_b16 a[76:77], v213 offset:22528
    ds_read_b64_tr_b16 a[78:79], v213 offset:23552
    ds_read_b128 a[44:47], v236 offset:6144
    buffer_store_dwordx4 v[64:67], v1, s[76:79], s8 offen offset:2048 sc1
    v_cvt_pk_bf16_f32 v72, v72, v73
    v_mfma_f32_32x32x16_bf16 v[176:191], a[204:207], a[12:15], v[176:191]
    ds_read_b64_tr_b16 a[80:81], v213 offset:24576
    ds_read_b64_tr_b16 a[82:83], v213 offset:25600
    ds_read_b128 a[48:51], v236 offset:8192
    ds_read_b64_tr_b16 a[84:85], v213 offset:26624
    ds_read_b64_tr_b16 a[86:87], v213 offset:27648
    v_cvt_pk_bf16_f32 v73, v74, v75
    v_cvt_pk_bf16_f32 v74, v76, v77
    v_cvt_pk_bf16_f32 v75, v78, v79
    v_mfma_f32_32x32x16_bf16 v[176:191], a[208:211], a[16:19], v[176:191]
    ds_read_b128 a[52:55], v236 offset:10240
    ds_read_b64_tr_b16 a[88:89], v213 offset:28672
    ds_read_b64_tr_b16 a[90:91], v213 offset:29696
    ds_read_b128 a[56:59], v236 offset:12288
    buffer_store_dwordx4 v[72:75], v1, s[76:79], s8 offen offset:3072 sc1
    v_mfma_f32_32x32x16_bf16 v[176:191], a[212:215], a[20:23], v[176:191]
    ds_read_b64_tr_b16 a[92:93], v213 offset:30720
    ds_read_b64_tr_b16 a[94:95], v213 offset:31744
    ds_read_b128 a[60:63], v236 offset:14336
    v_mfma_f32_32x32x16_bf16 v[176:191], a[216:219], a[24:27], v[176:191]
    v_mfma_f32_32x32x16_bf16 v[176:191], a[220:223], a[28:31], v[176:191]
    s_waitcnt lgkmcnt(0)
    s_barrier
    v_mfma_f32_32x32x16_bf16 v[176:191], a[32:35], a[64:67], v[176:191]
    ds_read_b128 a[0:3], v196 offset:49152
    ds_read_b64_tr_b16 a[192:193], v232 offset:0
    ds_read_b64_tr_b16 a[194:195], v234 offset:512
    ds_read_b128 a[4:7], v197 offset:49152
    v_mfma_f32_32x32x16_bf16 v[176:191], a[36:39], a[68:71], v[176:191]
    ds_read_b64_tr_b16 a[196:197], v232 offset:2048
    ds_read_b64_tr_b16 a[198:199], v234 offset:2560
    ds_read_b128 a[8:11], v198 offset:49152
    ds_read_b64_tr_b16 a[200:201], v232 offset:4096
    ds_read_b64_tr_b16 a[202:203], v234 offset:4608
    v_mfma_f32_32x32x16_bf16 v[176:191], a[40:43], a[72:75], v[176:191]
    ds_read_b128 a[12:15], v199 offset:49152
    ds_read_b64_tr_b16 a[204:205], v232 offset:6144
    ds_read_b64_tr_b16 a[206:207], v234 offset:6656
    s_waitcnt vmcnt(4)
    v_cmp_eq_u32 vcc, -1, v6
    s_cbranch_vccz L_got0
    s_mov_b32 s100, 65536
L_get0:
    buffer_load_dword v6, v254, s[76:79], 0 offen offset:0 sc1
    s_sub_u32 s100, s100, 1
    s_cbranch_scc1 L_got0
    s_waitcnt vmcnt(0)
    v_cmp_eq_u32 vcc, -1, v6
    s_cbranch_vccnz L_get0
L_got0:
    v_mfma_f32_32x32x16_bf16 v[176:191], a[44:47], a[76:79], v[176:191]
    ds_read_b128 a[16:19], v196 offset:57344
    ds_read_b64_tr_b16 a[208:209], v232 offset:8192
    ds_read_b64_tr_b16 a[210:211], v234 offset:8704
    ds_read_b128 a[20:23], v197 offset:57344
    buffer_load_dwordx4 v[16:19], v1, s[76:79], s9 offen offset:0 sc1
    v_mfma_f32_32x32x16_bf16 v[176:191], a[48:51], a[80:83], v[176:191]
    ds_read_b64_tr_b16 a[212:213], v232 offset:10240
    ds_read_b64_tr_b16 a[214:215], v234 offset:10752
    ds_read_b128 a[24:27], v198 offset:57344
    ds_read_b64_tr_b16 a[216:217], v232 offset:12288
    ds_read_b64_tr_b16 a[218:219], v234 offset:12800
    v_mfma_f32_32x32x16_bf16 v[176:191], a[52:55], a[84:87], v[176:191]
    ds_read_b128 a[28:31], v199 offset:57344
    ds_read_b64_tr_b16 a[220:221], v232 offset:14336
    ds_read_b64_tr_b16 a[222:223], v234 offset:14848
    buffer_load_dwordx4 v[20:23], v1, s[76:79], s9 offen offset:1024 sc1
    v_mfma_f32_32x32x16_bf16 v[176:191], a[56:59], a[88:91], v[176:191]
    v_mfma_f32_32x32x16_bf16 v[176:191], a[60:63], a[92:95], v[176:191]
    s_waitcnt lgkmcnt(0)
    s_nop 0
    buffer_load_dwordx4 v[24:27], v228, s[76:79], s9 offen offset:0 sc1
    v_mfma_f32_32x32x16_bf16 v[176:191], a[192:195], a[0:3], v[176:191]
    v_mfma_f32_32x32x16_bf16 v[176:191], a[196:199], a[4:7], v[176:191]
    buffer_load_dwordx4 v[28:31], v228, s[76:79], s9 offen offset:1024 sc1
    v_mfma_f32_32x32x16_bf16 v[176:191], a[200:203], a[8:11], v[176:191]
    buffer_load_dword v216, v254, s[76:79], 0 offen offset:128 sc1
    v_mfma_f32_32x32x16_bf16 v[176:191], a[204:207], a[12:15], v[176:191]
    s_waitcnt vmcnt(5)
    buffer_store_dwordx4 v[2:5], v229, s[76:79], s27 offen sc1
    v_mfma_f32_32x32x16_bf16 v[176:191], a[208:211], a[16:19], v[176:191]
    v_mfma_f32_32x32x16_bf16 v[176:191], a[212:215], a[20:23], v[176:191]
    v_mfma_f32_32x32x16_bf16 v[176:191], a[216:219], a[24:27], v[176:191]
    v_mfma_f32_32x32x16_bf16 v[176:191], a[220:223], a[28:31], v[176:191]
    s_waitcnt vmcnt(1)
    v_cmp_eq_u32 vcc, -1, v216
    s_cbranch_vccz L_got1
    s_mov_b32 s100, 65536
L_get1:
    buffer_load_dword v216, v254, s[76:79], 0 offen offset:128 sc1
    s_sub_u32 s100, s100, 1
    s_cbranch_scc1 L_got1
    s_waitcnt vmcnt(0)
    v_cmp_eq_u32_e64 vcc, -1, v216
    s_cbranch_vccnz L_get1
L_got1:
    buffer_load_dwordx4 v[32:35], v1, s[76:79], s10 offen offset:0 sc1
    buffer_load_dwordx4 v[36:39], v1, s[76:79], s10 offen offset:1024 sc1
    buffer_load_dwordx4 v[40:43], v228, s[76:79], s10 offen offset:0 sc1
    buffer_load_dwordx4 v[44:47], v228, s[76:79], s10 offen offset:1024 sc1
    buffer_load_dword v217, v254, s[76:79], 0 offen offset:256 sc1
    s_waitcnt vmcnt(0)
    v_cmp_eq_u32 vcc, -1, v217
    s_cbranch_vccz L_got2
    s_mov_b32 s100, 65536
L_get2:
    buffer_load_dword v217, v254, s[76:79], 0 offen offset:256 sc1
    s_sub_u32 s100, s100, 1
    s_cbranch_scc1 L_got2
    s_waitcnt vmcnt(0)
    v_cmp_eq_u32 vcc, -1, v217
    s_cbranch_vccnz L_get2
L_got2:
    buffer_load_dwordx4 v[80:83], v1, s[76:79], s11 offen offset:0 sc1
    buffer_load_dwordx4 v[88:91], v228, s[76:79], s11 offen offset:0 sc1
    buffer_load_dwordx4 v[84:87], v1, s[76:79], s11 offen offset:1024 sc1
    buffer_load_dwordx4 v[92:95], v228, s[76:79], s11 offen offset:1024 sc1
    v_dot2_f32_bf16 v176, v16, s21, v176
    v_dot2_f32_bf16 v177, v16, s22, v177
    v_dot2_f32_bf16 v178, v17, s21, v178
    v_dot2_f32_bf16 v179, v17, s22, v179
    v_dot2_f32_bf16 v180, v18, s21, v180
    v_dot2_f32_bf16 v181, v18, s22, v181
    v_dot2_f32_bf16 v182, v19, s21, v182
    v_dot2_f32_bf16 v183, v19, s22, v183
    v_dot2_f32_bf16 v184, v20, s21, v184
    v_dot2_f32_bf16 v185, v20, s22, v185
    v_dot2_f32_bf16 v186, v21, s21, v186
    v_dot2_f32_bf16 v187, v21, s22, v187
    v_dot2_f32_bf16 v188, v22, s21, v188
    v_dot2_f32_bf16 v189, v22, s22, v189
    v_dot2_f32_bf16 v190, v23, s21, v190
    v_dot2_f32_bf16 v191, v23, s22, v191
    v_dot2_f32_bf16 v176, v24, s21, v176
    v_dot2_f32_bf16 v177, v24, s22, v177
    v_dot2_f32_bf16 v178, v25, s21, v178
    v_dot2_f32_bf16 v179, v25, s22, v179
    v_dot2_f32_bf16 v180, v26, s21, v180
    v_dot2_f32_bf16 v181, v26, s22, v181
    v_dot2_f32_bf16 v182, v27, s21, v182
    v_dot2_f32_bf16 v183, v27, s22, v183
    v_dot2_f32_bf16 v184, v28, s21, v184
    v_dot2_f32_bf16 v185, v28, s22, v185
    v_dot2_f32_bf16 v186, v29, s21, v186
    v_dot2_f32_bf16 v187, v29, s22, v187
    v_dot2_f32_bf16 v188, v30, s21, v188
    v_dot2_f32_bf16 v189, v30, s22, v189
    v_dot2_f32_bf16 v190, v31, s21, v190
    v_dot2_f32_bf16 v191, v31, s22, v191
    v_dot2_f32_bf16 v176, v32, s21, v176
    v_dot2_f32_bf16 v177, v32, s22, v177
    v_dot2_f32_bf16 v178, v33, s21, v178
    v_dot2_f32_bf16 v179, v33, s22, v179
    v_dot2_f32_bf16 v180, v34, s21, v180
    v_dot2_f32_bf16 v181, v34, s22, v181
    v_dot2_f32_bf16 v182, v35, s21, v182
    v_dot2_f32_bf16 v183, v35, s22, v183
    v_dot2_f32_bf16 v184, v36, s21, v184
    v_dot2_f32_bf16 v185, v36, s22, v185
    v_dot2_f32_bf16 v186, v37, s21, v186
    v_dot2_f32_bf16 v187, v37, s22, v187
    v_dot2_f32_bf16 v188, v38, s21, v188
    v_dot2_f32_bf16 v189, v38, s22, v189
    v_dot2_f32_bf16 v190, v39, s21, v190
    v_dot2_f32_bf16 v191, v39, s22, v191
    v_dot2_f32_bf16 v176, v40, s21, v176
    v_dot2_f32_bf16 v177, v40, s22, v177
    v_dot2_f32_bf16 v178, v41, s21, v178
    v_dot2_f32_bf16 v179, v41, s22, v179
    v_dot2_f32_bf16 v180, v42, s21, v180
    v_dot2_f32_bf16 v181, v42, s22, v181
    v_dot2_f32_bf16 v182, v43, s21, v182
    v_dot2_f32_bf16 v183, v43, s22, v183
    v_dot2_f32_bf16 v184, v44, s21, v184
    v_dot2_f32_bf16 v185, v44, s22, v185
    v_dot2_f32_bf16 v186, v45, s21, v186
    v_dot2_f32_bf16 v187, v45, s22, v187
    v_dot2_f32_bf16 v188, v46, s21, v188
    v_dot2_f32_bf16 v189, v46, s22, v189
    v_dot2_f32_bf16 v190, v47, s21, v190
    v_dot2_f32_bf16 v191, v47, s22, v191
    s_waitcnt vmcnt(3)
    s_nop 0
    v_dot2_f32_bf16 v176, v80, s21, v176
    v_dot2_f32_bf16 v177, v80, s22, v177
    v_dot2_f32_bf16 v178, v81, s21, v178
    v_dot2_f32_bf16 v179, v81, s22, v179
    v_dot2_f32_bf16 v180, v82, s21, v180
    v_dot2_f32_bf16 v181, v82, s22, v181
    v_dot2_f32_bf16 v182, v83, s21, v182
    v_dot2_f32_bf16 v183, v83, s22, v183
    s_waitcnt vmcnt(2)
    s_nop 0
    v_dot2_f32_bf16 v176, v88, s21, v176
    v_dot2_f32_bf16 v177, v88, s22, v177
    v_dot2_f32_bf16 v178, v89, s21, v178
    v_dot2_f32_bf16 v179, v89, s22, v179
    v_dot2_f32_bf16 v180, v90, s21, v180
    v_dot2_f32_bf16 v181, v90, s22, v181
    v_dot2_f32_bf16 v182, v91, s21, v182
    v_dot2_f32_bf16 v183, v91, s22, v183
    v_pk_mul_f32 v[176:177], v[176:177], s[24:25]
    v_pk_mul_f32 v[178:179], v[178:179], s[24:25]
    v_pk_mul_f32 v[180:181], v[180:181], s[24:25]
    v_pk_mul_f32 v[182:183], v[182:183], s[24:25]
    buffer_store_dword v176, v5, s[68:71], s13 offen offset:0 sc1 nt
    buffer_store_dword v177, v5, s[68:71], s13 offen offset:1792 sc1 nt
    buffer_store_dword v178, v5, s[68:71], s14 offen offset:0 sc1 nt
    buffer_store_dword v179, v5, s[68:71], s14 offen offset:1792 sc1 nt
    buffer_store_dword v180, v5, s[68:71], s15 offen offset:0 sc1 nt
    buffer_store_dword v181, v5, s[68:71], s15 offen offset:1792 sc1 nt
    buffer_store_dword v182, v5, s[68:71], s16 offen offset:0 sc1 nt
    buffer_store_dword v183, v5, s[68:71], s16 offen offset:1792 sc1 nt
    s_waitcnt vmcnt(9)
    s_nop 0
    v_dot2_f32_bf16 v184, v84, s21, v184
    v_dot2_f32_bf16 v185, v84, s22, v185
    v_dot2_f32_bf16 v186, v85, s21, v186
    v_dot2_f32_bf16 v187, v85, s22, v187
    v_dot2_f32_bf16 v188, v86, s21, v188
    v_dot2_f32_bf16 v189, v86, s22, v189
    v_dot2_f32_bf16 v190, v87, s21, v190
    v_dot2_f32_bf16 v191, v87, s22, v191
    s_waitcnt vmcnt(8)
    s_nop 0
    v_dot2_f32_bf16 v184, v92, s21, v184
    v_dot2_f32_bf16 v185, v92, s22, v185
    v_dot2_f32_bf16 v186, v93, s21, v186
    v_dot2_f32_bf16 v187, v93, s22, v187
    v_dot2_f32_bf16 v188, v94, s21, v188
    v_dot2_f32_bf16 v189, v94, s22, v189
    v_dot2_f32_bf16 v190, v95, s21, v190
    v_dot2_f32_bf16 v191, v95, s22, v191
    v_pk_mul_f32 v[184:185], v[184:185], s[24:25]
    v_pk_mul_f32 v[186:187], v[186:187], s[24:25]
    v_pk_mul_f32 v[188:189], v[188:189], s[24:25]
    v_pk_mul_f32 v[190:191], v[190:191], s[24:25]
    buffer_store_dword v184, v5, s[68:71], s17 offen offset:0 sc1 nt
    buffer_store_dword v185, v5, s[68:71], s17 offen offset:1792 sc1 nt
    buffer_store_dword v186, v5, s[68:71], s18 offen offset:0 sc1 nt
    buffer_store_dword v187, v5, s[68:71], s18 offen offset:1792 sc1 nt
    buffer_store_dword v188, v5, s[68:71], s19 offen offset:0 sc1 nt
    buffer_store_dword v189, v5, s[68:71], s19 offen offset:1792 sc1 nt
    buffer_store_dword v190, v5, s[68:71], s20 offen offset:0 sc1 nt
    buffer_store_dword v191, v5, s[68:71], s20 offen offset:1792 sc1 nt
    s_endpgm
L_ready_e:
    s_mov_b32 s100, 65536
L_ready_e_again:
    v_and_b32 v6, 0xc0, v1
    v_lshl_add_u32 v6, s90, 8, v6
    buffer_load_dword v6, v6, s[36:39], 0 offen sc1
    s_waitcnt vmcnt(0)
    v_cmp_eq_u32 s[96:97], s90, v6
    s_nop 0
    s_cmp_lg_u64 s[96:97], 0
    s_cbranch_scc0 L_ready_e_ok
    s_sub_u32 s100, s100, 1
    s_cmp_lg_u32 s100, 0
    s_cbranch_scc1 L_ready_e_again
    s_branch L_ready_e_ok
L_carry_retry:
    s_mov_b32 s100, 65536
L_carry_again:
    buffer_load_dwordx2 v[190:191], v4, s[72:75], 0 offen offset:896 sc1
    buffer_load_dwordx2 v[188:189], v4, s[72:75], 0 offen offset:768 sc1
    buffer_load_dwordx2 v[186:187], v4, s[72:75], 0 offen offset:640 sc1
    buffer_load_dwordx2 v[184:185], v4, s[72:75], 0 offen offset:512 sc1
    buffer_load_dwordx2 v[182:183], v4, s[72:75], 0 offen offset:384 sc1
    buffer_load_dwordx2 v[180:181], v4, s[72:75], 0 offen offset:256 sc1
    buffer_load_dwordx2 v[178:179], v4, s[72:75], 0 offen offset:128 sc1
    buffer_load_dwordx2 v[176:177], v4, s[72:75], 0 offen offset:0 sc1
    s_waitcnt vmcnt(0)
    v_max_u32 v219, v176, v177
    v_max3_u32 v219, v178, v179, v219
    v_max3_u32 v219, v180, v181, v219
    v_max3_u32 v219, v182, v183, v219
    v_max3_u32 v219, v184, v185, v219
    v_max3_u32 v219, v186, v187, v219
    v_max3_u32 v219, v188, v189, v219
    v_max3_u32 v219, v190, v191, v219
    v_cmp_eq_u32 vcc, -1, v219
    s_cbranch_vccz L_carry_fold
    s_sub_u32 s100, s100, 1
    s_cmp_lg_u32 s100, 0
    s_cbranch_scc1 L_carry_again
L_carry_fold:
    v_fmac_f32 v188, v249, v190
    v_fmac_f32 v189, v249, v191
    v_fma_f32 v188, -v250, v191, v188
    v_fmac_f32 v189, v250, v190
    v_fmac_f32 v186, v249, v188
    v_fmac_f32 v187, v249, v189
    v_fma_f32 v186, -v250, v189, v186
    v_fmac_f32 v187, v250, v188
    v_fmac_f32 v184, v249, v186
    v_fmac_f32 v185, v249, v187
    v_fma_f32 v184, -v250, v187, v184
    v_fmac_f32 v185, v250, v186
    v_fmac_f32 v182, v249, v184
    v_fmac_f32 v183, v249, v185
    v_fma_f32 v182, -v250, v185, v182
    v_fmac_f32 v183, v250, v184
    v_fmac_f32 v180, v249, v182
    v_fmac_f32 v181, v249, v183
    v_fma_f32 v180, -v250, v183, v180
    v_fmac_f32 v181, v250, v182
    v_fmac_f32 v178, v249, v180
    v_fmac_f32 v179, v249, v181
    v_fma_f32 v178, -v250, v181, v178
    v_fmac_f32 v179, v250, v180
    v_fmac_f32 v176, v249, v178
    v_fmac_f32 v177, v249, v179
    v_fma_f32 v176, -v250, v179, v176
    v_fmac_f32 v177, v250, v178
    v_mul_f32 v179, v252, v176
    v_mul_f32 v178, v251, v176
    v_fma_f32 v179, -v251, v177, v179
    v_fmac_f32 v178, v252, v177
    s_nop 1
    s_branch L_carry_ok
L_ready_n:
    s_mov_b32 s100, 65536
L_ready_n_again:
    v_and_b32 v6, 0xc0, v1
    global_load_dword v6, v6, s[32:33] sc1
    s_waitcnt vmcnt(0)
    v_lshrrev_b32 v218, 9, v6
    v_cmp_eq_u32 s[96:97], 0, v218
    s_nop 0
    s_cmp_lg_u64 s[96:97], 0
    s_cbranch_scc0 L_ready_n_ok
    s_sub_u32 s100, s100, 1
    s_cmp_lg_u32 s100, 0
    s_cbranch_scc1 L_ready_n_again
    s_branch L_ready_n_ok
L_hot_end:
.section .rodata,"a"
.p2align 6
.amdhsa_kernel parallel_sum__ssm_conv_s5__dense_activation_mish__prompt_kernel
  .amdhsa_next_free_vgpr 512
  .amdhsa_next_free_sgpr 102
  .amdhsa_accum_offset 256
  .amdhsa_group_segment_fixed_size 0
  .amdhsa_kernarg_size 128
  .amdhsa_user_sgpr_count 2
  .amdhsa_user_sgpr_kernarg_segment_ptr 1
  .amdhsa_system_sgpr_workgroup_id_x 1
  .amdhsa_float_denorm_mode_32 3
.end_amdhsa_kernel
```
